```python
import torch

def _softmax(x, axis=-1):
    return torch.softmax(x, dim=axis)
def _gelu(x):
    return torch.nn.functional.gelu(x, approximate="tanh")
def _silu(x):
    return torch.nn.functional.silu(x)
def _sigmoid(x):
    return torch.sigmoid(x)
def _layernorm(x, axis=-1, eps=1e-5):
    m = x.mean(dim=axis, keepdim=True)
    v = x.var(dim=axis, keepdim=True, unbiased=False)
    return (x - m) / torch.sqrt(v + eps)
def _scatter_add(tgt, idx, src, axis=0):
    return tgt.clone().index_add_(axis, idx, src)
def _segment_sum(src, seg, n):
    out = torch.zeros((n,) + src.shape[1:], dtype=src.dtype)
    return out.index_add_(0, seg, src)
def _pad(x, pw):
    flat = tuple(v for pair in reversed(pw) for v in pair)
    return torch.nn.functional.pad(x, flat)

kernel_name = 'standalone__graph_attention_gat__graph'

def setup_inputs():

    _w = (lambda a: (lambda t: t.to(torch.bfloat16) if t.is_floating_point() else t)(torch.as_tensor(a)))
    N, deg, D = 10000, 16, 256
    H = 4
    E = N * deg
    return {
        "x": _w((lambda *s: torch.randn(*s, dtype=torch.bfloat16) * 0.4)(N, D) * 0.1),
        "src": _w((lambda lo, hi, *s: torch.randint(lo, hi, s))(0, N, E).to(torch.int64)),
        "dst": _w((lambda lo, hi, *s: torch.randint(lo, hi, s))(0, N, E).to(torch.int64)),
        "w": _w((lambda *s: torch.randn(*s, dtype=torch.bfloat16) * 1.6)(H, D, D) * (1.0 / D ** 0.5)),
        "a_src": _w((lambda *s: torch.randn(*s, dtype=torch.bfloat16) * 1.6)(H, D) * 0.1),
        "a_dst": _w((lambda *s: torch.randn(*s, dtype=torch.bfloat16) * 1.6)(H, D) * 0.1),
    }

def reference(x, src, dst, w, a_src, a_dst):
    N, D = x.shape
    H = w.shape[0]
    h = torch.einsum('nd,hdf->nhf', x, w)
    hs = h[src]
    hd = h[dst]
    e = torch.einsum('ehf,hf->eh', hs, a_src) + torch.einsum('ehf,hf->eh', hd, a_dst)
    e = torch.where(e > 0, e, 0.2 * e)
    exp_e = torch.exp(e)
    denom = _segment_sum(exp_e, dst, N) + 1e-9
    alpha = exp_e / denom[dst]
    out = _segment_sum(alpha[:, :, None] * hs, dst, N)
    return out.mean(1)
```

```asm
; @launch kernel=gat_prep_kernel grid=(288,1,1) block=(512,1,1) lds=34816
; @launch kernel=standalone__graph_attention_gat__graph_kernel grid=(250,1,1) block=(512,1,1) lds=160256
.amdgcn_target "amdgcn-amd-amdhsa--gfx950"
.text
.globl gat_prep_kernel
.p2align 8
.type gat_prep_kernel,@function
gat_prep_kernel:
    s_cmp_ge_u32 s2, 288
    s_cbranch_scc1 K1_END
    s_cmp_ge_u32 s2, 160
    s_cbranch_scc1 K1_PF
    s_load_dwordx4 s[4:7], s[0:1], 8
    s_load_dwordx4 s[8:11], s[0:1], 24
    s_load_dwordx2 s[12:13], s[0:1], 40
    s_load_dwordx2 s[14:15], s[0:1], 64
    s_cmp_ge_u32 s2, 128
    s_cbranch_scc1 K1_V
    s_cmp_ge_u32 s2, 64
    s_cbranch_scc1 K1_REPACK
    v_lshlrev_b32 v1, 4, v0
    v_mov_b32 v2, 2147483647
    v_mov_b32 v3, 2147483647
    v_mov_b32 v4, 2147483647
    v_mov_b32 v5, 2147483647
    ds_write_b128 v1, v[2:5] offset:0
    ds_write_b128 v1, v[2:5] offset:8192
    ds_write_b128 v1, v[2:5] offset:16384
    ds_write_b128 v1, v[2:5] offset:24576
    v_lshlrev_b32 v6, 2, v0
    v_mov_b32 v7, 0
    ds_write_b32 v6, v7 offset:32768
    s_mul_i32 s28, s2, 10000
    s_add_u32 s29, s28, 2000
    s_add_u32 s30, s28, 4000
    s_add_u32 s31, s28, 6000
    s_add_u32 s32, s28, 8000
    v_cmp_gt_u32 vcc, 500, v0
    s_waitcnt lgkmcnt(0)
    s_mov_b32 s20, s6
    s_and_b32 s21, s7, 0xffff
    s_mov_b32 s22, 640000
    s_mov_b32 s23, 0x00020000
    s_mov_b32 s16, s4
    s_and_b32 s17, s5, 0xffff
    s_mov_b32 s18, 640000
    s_mov_b32 s19, 0x00020000
    s_and_saveexec_b64 s[34:35], vcc
    buffer_load_dword v10, v6, s[20:23], s28 offen
    buffer_load_dword v11, v6, s[20:23], s29 offen
    buffer_load_dword v12, v6, s[20:23], s30 offen
    buffer_load_dword v13, v6, s[20:23], s31 offen
    buffer_load_dword v14, v6, s[20:23], s32 offen
    buffer_load_dword v15, v6, s[16:19], s28 offen
    buffer_load_dword v16, v6, s[16:19], s29 offen
    buffer_load_dword v17, v6, s[16:19], s30 offen
    buffer_load_dword v18, v6, s[16:19], s31 offen
    buffer_load_dword v19, v6, s[16:19], s32 offen
    s_mov_b32 s24, s14
    s_and_b32 s25, s15, 0xffff
    s_mov_b32 s26, 2048000
    s_mov_b32 s27, 0x00020000
    v_mov_b32 v8, 1
    v_mov_b32 v9, 34812
    s_barrier
    s_waitcnt vmcnt(5)
    v_mul_u32_u24 v20, 52429, v10
    v_lshrrev_b32 v20, 18, v20
    v_mad_i32_i24 v21, v20, -5, v10
    v_lshrrev_b32 v30, 3, v20
    v_lshlrev_b32 v24, 2, v30
    ds_add_rtn_u32 v35, v24, v8 offset:32768
    v_and_b32 v23, 7, v20
    v_cmp_lt_u32 vcc, 2, v21
    v_lshlrev_b32 v23, 4, v23
    v_add_u32 v22, 5, v21
    v_cndmask_b32 v21, v21, v22, vcc
    v_add_u32 v10, v23, v21
    v_mul_u32_u24 v20, 52429, v11
    v_lshrrev_b32 v20, 18, v20
    v_mad_i32_i24 v21, v20, -5, v11
    v_lshrrev_b32 v31, 3, v20
    v_lshlrev_b32 v24, 2, v31
    ds_add_rtn_u32 v36, v24, v8 offset:32768
    v_and_b32 v23, 7, v20
    v_cmp_lt_u32 vcc, 2, v21
    v_lshlrev_b32 v23, 4, v23
    v_add_u32 v22, 5, v21
    v_cndmask_b32 v21, v21, v22, vcc
    v_add_u32 v11, v23, v21
    v_mul_u32_u24 v20, 52429, v12
    v_lshrrev_b32 v20, 18, v20
    v_mad_i32_i24 v21, v20, -5, v12
    v_lshrrev_b32 v32, 3, v20
    v_lshlrev_b32 v24, 2, v32
    ds_add_rtn_u32 v37, v24, v8 offset:32768
    v_and_b32 v23, 7, v20
    v_cmp_lt_u32 vcc, 2, v21
    v_lshlrev_b32 v23, 4, v23
    v_add_u32 v22, 5, v21
    v_cndmask_b32 v21, v21, v22, vcc
    v_add_u32 v12, v23, v21
    v_mul_u32_u24 v20, 52429, v13
    v_lshrrev_b32 v20, 18, v20
    v_mad_i32_i24 v21, v20, -5, v13
    v_lshrrev_b32 v33, 3, v20
    v_lshlrev_b32 v24, 2, v33
    ds_add_rtn_u32 v38, v24, v8 offset:32768
    v_and_b32 v23, 7, v20
    v_cmp_lt_u32 vcc, 2, v21
    v_lshlrev_b32 v23, 4, v23
    v_add_u32 v22, 5, v21
    v_cndmask_b32 v21, v21, v22, vcc
    v_add_u32 v13, v23, v21
    v_mul_u32_u24 v20, 52429, v14
    v_lshrrev_b32 v20, 18, v20
    v_mad_i32_i24 v21, v20, -5, v14
    v_lshrrev_b32 v34, 3, v20
    v_lshlrev_b32 v24, 2, v34
    ds_add_rtn_u32 v39, v24, v8 offset:32768
    v_and_b32 v23, 7, v20
    v_cmp_lt_u32 vcc, 2, v21
    v_lshlrev_b32 v23, 4, v23
    v_add_u32 v22, 5, v21
    v_cndmask_b32 v21, v21, v22, vcc
    v_add_u32 v14, v23, v21
    s_waitcnt vmcnt(0)
    v_lshl_or_b32 v15, v15, 9, v10
    v_lshl_or_b32 v16, v16, 9, v11
    v_lshl_or_b32 v17, v17, 9, v12
    v_lshl_or_b32 v18, v18, 9, v13
    v_lshl_or_b32 v19, v19, 9, v14
    s_waitcnt lgkmcnt(0)
    v_cmp_gt_u32 vcc, 32, v35
    v_lshlrev_b32 v30, 7, v30
    v_lshl_add_u32 v30, v35, 2, v30
    v_cndmask_b32 v30, v9, v30, vcc
    ds_write_b32 v30, v15
    v_cmp_gt_u32 vcc, 32, v36
    v_lshlrev_b32 v31, 7, v31
    v_lshl_add_u32 v31, v36, 2, v31
    v_cndmask_b32 v31, v9, v31, vcc
    ds_write_b32 v31, v16
    v_cmp_gt_u32 vcc, 32, v37
    v_lshlrev_b32 v32, 7, v32
    v_lshl_add_u32 v32, v37, 2, v32
    v_cndmask_b32 v32, v9, v32, vcc
    ds_write_b32 v32, v17
    v_cmp_gt_u32 vcc, 32, v38
    v_lshlrev_b32 v33, 7, v33
    v_lshl_add_u32 v33, v38, 2, v33
    v_cndmask_b32 v33, v9, v33, vcc
    ds_write_b32 v33, v18
    v_cmp_gt_u32 vcc, 32, v39
    v_lshlrev_b32 v34, 7, v34
    v_lshl_add_u32 v34, v39, 2, v34
    v_cndmask_b32 v34, v9, v34, vcc
    ds_write_b32 v34, v19
    s_mov_b64 exec, s[34:35]
    v_lshrrev_b32 v2, 3, v0
    v_lshlrev_b32 v2, 2, v2
    v_and_b32 v3, 7, v0
    v_cmp_eq_u32 s[36:37], 7, v3
    v_mov_b32 v4, 2147483639
    s_mul_i32 s28, s2, 32000
    v_add_u32 v5, 0, v1
    v_add_u32 v6, 8192, v1
    v_add_u32 v7, 16384, v1
    v_add_u32 v8, 24576, v1
    s_waitcnt lgkmcnt(0)
    s_barrier
    ds_read_b128 v[10:13], v1 offset:0
    ds_read_b32 v30, v2 offset:32768
    ds_read_b128 v[14:17], v1 offset:8192
    ds_read_b32 v31, v2 offset:33024
    ds_read_b128 v[18:21], v1 offset:16384
    ds_read_b32 v32, v2 offset:33280
    ds_read_b128 v[22:25], v1 offset:24576
    ds_read_b32 v33, v2 offset:33536
    s_waitcnt lgkmcnt(0)
    v_cmp_lt_u32 vcc, 32, v30
    s_and_b64 vcc, vcc, s[36:37]
    s_nop 1
    v_cndmask_b32 v13, v13, v4, vcc
    v_cmp_lt_u32 vcc, 32, v31
    s_and_b64 vcc, vcc, s[36:37]
    s_nop 1
    v_cndmask_b32 v17, v17, v4, vcc
    v_cmp_lt_u32 vcc, 32, v32
    s_and_b64 vcc, vcc, s[36:37]
    s_nop 1
    v_cndmask_b32 v21, v21, v4, vcc
    v_cmp_lt_u32 vcc, 32, v33
    s_and_b64 vcc, vcc, s[36:37]
    s_nop 1
    v_cndmask_b32 v25, v25, v4, vcc
    buffer_store_dwordx4 v[10:13], v5, s[24:27], s28 offen
    buffer_store_dwordx4 v[14:17], v6, s[24:27], s28 offen
    buffer_store_dwordx4 v[18:21], v7, s[24:27], s28 offen
    v_cmp_gt_u32 vcc, 464, v0
    s_and_saveexec_b64 s[34:35], vcc
    s_cbranch_execz K1_END
    buffer_store_dwordx4 v[22:25], v8, s[24:27], s28 offen
    s_branch K1_END
K1_REPACK:
    v_lshrrev_b32 v1, 6, v0
    v_and_b32 v2, 63, v0
    v_readfirstlane_b32 s28, v1
    s_sub_u32 s29, s2, 64
    s_lshl_b32 s29, s29, 3
    s_add_u32 s29, s29, s28
    s_lshr_b32 s30, s29, 4
    s_lshr_b32 s31, s29, 2
    s_and_b32 s31, s31, 3
    s_and_b32 s32, s29, 3
    s_and_b32 s33, s31, 1
    s_lshl_b32 s33, s33, 9
    s_lshl_b32 s34, s30, 3
    s_add_u32 s33, s33, s34
    s_lshr_b32 s34, s31, 1
    s_lshl_b32 s34, s34, 2
    s_add_u32 s33, s33, s34
    s_lshl_b32 s33, s33, 9
    s_lshl_b32 s34, s32, 7
    s_add_u32 s33, s33, s34
    s_add_u32 s36, s33, 131072
    v_lshlrev_b32 v3, 1, v2
    s_waitcnt lgkmcnt(0)
    s_mov_b32 s16, s8
    s_and_b32 s17, s9, 0xffff
    s_mov_b32 s18, 524288
    s_mov_b32 s19, 0x00020000
    buffer_load_ushort v10, v3, s[16:19], s33 offen offset:0
    buffer_load_ushort v11, v3, s[16:19], s33 offen offset:512
    buffer_load_ushort v12, v3, s[16:19], s33 offen offset:1024
    buffer_load_ushort v13, v3, s[16:19], s33 offen offset:1536
    buffer_load_ushort v14, v3, s[16:19], s36 offen offset:0
    buffer_load_ushort v15, v3, s[16:19], s36 offen offset:512
    buffer_load_ushort v16, v3, s[16:19], s36 offen offset:1024
    buffer_load_ushort v17, v3, s[16:19], s36 offen offset:1536
    s_mov_b32 s24, s14
    s_and_b32 s25, s15, 0xffff
    s_mov_b32 s26, 2625536
    s_mov_b32 s27, 0x00020000
    s_lshl_b32 s34, s32, 6
    s_add_u32 s34, s34, s30
    s_lshl_b32 s34, s34, 11
    s_lshl_b32 s35, s31, 8
    s_add_u32 s34, s34, s35
    s_add_u32 s34, s34, 2097152
    v_lshrrev_b32 v4, 5, v2
    v_lshlrev_b32 v4, 16, v4
    v_bfe_u32 v5, v2, 2, 1
    v_lshl_or_b32 v4, v5, 10, v4
    v_bfe_u32 v5, v2, 3, 2
    v_lshl_or_b32 v4, v5, 6, v4
    v_and_b32 v5, 3, v2
    v_lshl_or_b32 v4, v5, 4, v4
    s_waitcnt vmcnt(0)
    v_lshl_or_b32 v20, v11, 16, v10
    v_lshl_or_b32 v21, v13, 16, v12
    v_lshl_or_b32 v22, v15, 16, v14
    v_lshl_or_b32 v23, v17, 16, v16
    buffer_store_dwordx4 v[20:23], v4, s[24:27], s34 offen
    s_branch K1_END
K1_V:
    v_lshrrev_b32 v1, 4, v0
    v_and_b32 v2, 15, v0
    s_sub_u32 s29, s2, 128
    s_lshl_b32 s29, s29, 5
    v_add_u32 v1, s29, v1
    v_lshlrev_b32 v3, 9, v1
    v_lshl_add_u32 v3, v2, 5, v3
    v_lshrrev_b32 v4, 8, v1
    v_lshlrev_b32 v4, 9, v4
    v_lshl_add_u32 v4, v2, 5, v4
    s_waitcnt lgkmcnt(0)
    s_mov_b32 s16, s8
    s_and_b32 s17, s9, 0xffff
    s_mov_b32 s18, 524288
    s_mov_b32 s19, 0x00020000
    s_mov_b32 s20, s10
    s_and_b32 s21, s11, 0xffff
    s_mov_b32 s22, 2048
    s_mov_b32 s23, 0x00020000
    s_mov_b32 s28, s12
    s_and_b32 s29, s13, 0xffff
    s_mov_b32 s30, 2048
    s_mov_b32 s31, 0x00020000
    s_mov_b32 s24, s14
    s_and_b32 s25, s15, 0xffff
    s_mov_b32 s26, 2625536
    s_mov_b32 s27, 0x00020000
    buffer_load_dwordx4 v[8:11], v3, s[16:19], 0 offen
    buffer_load_dwordx4 v[12:15], v3, s[16:19], 0 offen offset:16
    buffer_load_dwordx4 v[16:19], v4, s[20:23], 0 offen
    buffer_load_dwordx4 v[20:23], v4, s[20:23], 0 offen offset:16
    buffer_load_dwordx4 v[24:27], v4, s[28:31], 0 offen
    buffer_load_dwordx4 v[28:31], v4, s[28:31], 0 offen offset:16
    v_mov_b32 v32, 0
    v_mov_b32 v33, 0
    s_waitcnt vmcnt(0)
    v_lshlrev_b32 v34, 16, v8
    v_and_b32 v35, 0xffff0000, v8
    v_lshlrev_b32 v36, 16, v16
    v_and_b32 v37, 0xffff0000, v16
    v_lshlrev_b32 v38, 16, v24
    v_and_b32 v39, 0xffff0000, v24
    v_fmac_f32 v32, v34, v36
    v_fmac_f32 v33, v34, v38
    v_fmac_f32 v32, v35, v37
    v_fmac_f32 v33, v35, v39
    v_lshlrev_b32 v34, 16, v9
    v_and_b32 v35, 0xffff0000, v9
    v_lshlrev_b32 v36, 16, v17
    v_and_b32 v37, 0xffff0000, v17
    v_lshlrev_b32 v38, 16, v25
    v_and_b32 v39, 0xffff0000, v25
    v_fmac_f32 v32, v34, v36
    v_fmac_f32 v33, v34, v38
    v_fmac_f32 v32, v35, v37
    v_fmac_f32 v33, v35, v39
    v_lshlrev_b32 v34, 16, v10
    v_and_b32 v35, 0xffff0000, v10
    v_lshlrev_b32 v36, 16, v18
    v_and_b32 v37, 0xffff0000, v18
    v_lshlrev_b32 v38, 16, v26
    v_and_b32 v39, 0xffff0000, v26
    v_fmac_f32 v32, v34, v36
    v_fmac_f32 v33, v34, v38
    v_fmac_f32 v32, v35, v37
    v_fmac_f32 v33, v35, v39
    v_lshlrev_b32 v34, 16, v11
    v_and_b32 v35, 0xffff0000, v11
    v_lshlrev_b32 v36, 16, v19
    v_and_b32 v37, 0xffff0000, v19
    v_lshlrev_b32 v38, 16, v27
    v_and_b32 v39, 0xffff0000, v27
    v_fmac_f32 v32, v34, v36
    v_fmac_f32 v33, v34, v38
    v_fmac_f32 v32, v35, v37
    v_fmac_f32 v33, v35, v39
    v_lshlrev_b32 v34, 16, v12
    v_and_b32 v35, 0xffff0000, v12
    v_lshlrev_b32 v36, 16, v20
    v_and_b32 v37, 0xffff0000, v20
    v_lshlrev_b32 v38, 16, v28
    v_and_b32 v39, 0xffff0000, v28
    v_fmac_f32 v32, v34, v36
    v_fmac_f32 v33, v34, v38
    v_fmac_f32 v32, v35, v37
    v_fmac_f32 v33, v35, v39
    v_lshlrev_b32 v34, 16, v13
    v_and_b32 v35, 0xffff0000, v13
    v_lshlrev_b32 v36, 16, v21
    v_and_b32 v37, 0xffff0000, v21
    v_lshlrev_b32 v38, 16, v29
    v_and_b32 v39, 0xffff0000, v29
    v_fmac_f32 v32, v34, v36
    v_fmac_f32 v33, v34, v38
    v_fmac_f32 v32, v35, v37
    v_fmac_f32 v33, v35, v39
    v_lshlrev_b32 v34, 16, v14
    v_and_b32 v35, 0xffff0000, v14
    v_lshlrev_b32 v36, 16, v22
    v_and_b32 v37, 0xffff0000, v22
    v_lshlrev_b32 v38, 16, v30
    v_and_b32 v39, 0xffff0000, v30
    v_fmac_f32 v32, v34, v36
    v_fmac_f32 v33, v34, v38
    v_fmac_f32 v32, v35, v37
    v_fmac_f32 v33, v35, v39
    v_lshlrev_b32 v34, 16, v15
    v_and_b32 v35, 0xffff0000, v15
    v_lshlrev_b32 v36, 16, v23
    v_and_b32 v37, 0xffff0000, v23
    v_lshlrev_b32 v38, 16, v31
    v_and_b32 v39, 0xffff0000, v31
    v_fmac_f32 v32, v34, v36
    v_fmac_f32 v33, v34, v38
    v_fmac_f32 v32, v35, v37
    v_fmac_f32 v33, v35, v39
    s_nop 1
    v_add_f32_dpp v32, v32, v32 quad_perm:[1,0,3,2] row_mask:0xf bank_mask:0xf
    v_add_f32_dpp v33, v33, v33 quad_perm:[1,0,3,2] row_mask:0xf bank_mask:0xf
    s_nop 1
    v_add_f32_dpp v32, v32, v32 quad_perm:[2,3,0,1] row_mask:0xf bank_mask:0xf
    v_add_f32_dpp v33, v33, v33 quad_perm:[2,3,0,1] row_mask:0xf bank_mask:0xf
    s_nop 1
    v_add_f32_dpp v32, v32, v32 row_half_mirror row_mask:0xf bank_mask:0xf
    v_add_f32_dpp v33, v33, v33 row_half_mirror row_mask:0xf bank_mask:0xf
    s_nop 1
    v_add_f32_dpp v32, v32, v32 row_mirror row_mask:0xf bank_mask:0xf
    v_add_f32_dpp v33, v33, v33 row_mirror row_mask:0xf bank_mask:0xf
    v_cmp_eq_u32 vcc, 0, v2
    s_nop 1
    v_cndmask_b32 v32, v33, v32, vcc
    v_mul_f32 v32, 0x3fb8aa3b, v32
    v_cvt_pk_bf16_f32 v32, v32, v32
    v_lshlrev_b32 v5, 1, v1
    v_lshl_add_u32 v5, v2, 11, v5
    v_add_u32 v5, 2621440, v5
    v_cmp_gt_u32 vcc, 2, v2
    s_and_saveexec_b64 s[34:35], vcc
    s_cbranch_execz K1_END
    buffer_store_short v32, v5, s[24:27], 0 offen
    s_branch K1_END
K1_PF:
    s_load_dwordx2 s[4:5], s[0:1], 0
    s_load_dwordx2 s[6:7], s[0:1], 48
    v_lshlrev_b32 v1, 4, v0
    s_sub_u32 s29, s2, 160
    s_mov_b32 s30, s29
    s_mul_i32 s29, s29, 40960
    s_waitcnt lgkmcnt(0)
    s_mov_b32 s16, s4
    s_and_b32 s17, s5, 0xffff
    s_mov_b32 s18, 5120000
    s_mov_b32 s19, 0x00020000
    buffer_load_dwordx4 v[4:7], v1, s[16:19], s29 offen
    s_add_u32 s29, s29, 8192
    buffer_load_dwordx4 v[8:11], v1, s[16:19], s29 offen
    s_add_u32 s29, s29, 8192
    buffer_load_dwordx4 v[12:15], v1, s[16:19], s29 offen
    s_add_u32 s29, s29, 8192
    buffer_load_dwordx4 v[16:19], v1, s[16:19], s29 offen
    s_add_u32 s29, s29, 8192
    buffer_load_dwordx4 v[20:23], v1, s[16:19], s29 offen
    s_add_u32 s29, s29, 8192
    s_mov_b32 s20, s6
    s_and_b32 s21, s7, 0xffff
    s_mov_b32 s22, 5120000
    s_mov_b32 s23, 0x00020000
    s_mul_i32 s31, s30, 40960
    v_lshlrev_b32 v2, 6, v0
    v_and_b32 v2, 0x7000, v2
    buffer_load_dword v40, v2, s[20:23], s31 offen
    s_cmp_ge_u32 s30, 16
    s_cbranch_scc1 K1_PFW
    s_getpc_b64 s[32:33]
K1_PCREF:
    s_add_u32 s32, s32, standalone__graph_attention_gat__graph_kernel-K1_PCREF
    s_addc_u32 s33, s33, 0
    s_mov_b32 s34, K3_CODE_END-standalone__graph_attention_gat__graph_kernel
    s_mov_b32 s35, 0x00020000
    s_and_b32 s33, s33, 0xffff
    buffer_load_dwordx4 v[24:27], v1, s[32:35], 0 offen
    s_mov_b32 s37, 8192
    buffer_load_dwordx4 v[24:27], v1, s[32:35], s37 offen
    s_mov_b32 s38, 16384
    buffer_load_dwordx4 v[24:27], v1, s[32:35], s38 offen
K1_PFW:
    s_waitcnt vmcnt(0)
K1_END:
    s_endpgm
.globl standalone__graph_attention_gat__graph_kernel
.p2align 8
.type standalone__graph_attention_gat__graph_kernel,@function
standalone__graph_attention_gat__graph_kernel:
    s_cmp_ge_u32 s2, 250
    s_cbranch_scc1 K3_END
    s_load_dwordx2 s[12:13], s[0:1], 64
    s_load_dwordx4 s[4:7], s[0:1], 0
    s_load_dwordx2 s[8:9], s[0:1], 16
    s_load_dwordx2 s[10:11], s[0:1], 48
    v_lshrrev_b32 v16, 6, v0
    v_and_b32 v3, 63, v0
    v_and_b32 v1, 15, v0
    v_readfirstlane_b32 s36, v16
    v_bfe_u32 v2, v0, 4, 2
    v_lshlrev_b32 v17, 4, v0
    s_mov_b32 s62, 2147483647
    v_mov_b32 v24, s62
    v_mov_b32 v25, s62
    v_mov_b32 v26, s62
    v_mov_b32 v27, s62
    ds_write_b128 v17, v[24:27] offset:6400
    ds_write_b128 v17, v[24:27] offset:14592
    v_lshlrev_b32 v14, 2, v3
    v_mov_b32 v16, 0
    ds_write_b32 v14, v16 offset:0
    v_lshrrev_b32 v16, 3, v0
    v_mul_u32_u24 v16, 32000, v16
    v_and_b32 v14, 7, v0
    v_lshl_add_u32 v16, v14, 4, v16
    s_lshl_b32 s51, s2, 7
    v_lshlrev_b32 v14, 3, v0
    s_mov_b32 s56, 2621440
    s_waitcnt lgkmcnt(0)
    s_mov_b32 s20, s12
    s_and_b32 s21, s13, 0xffff
    s_mov_b32 s22, 2625536
    s_mov_b32 s23, 0x00020000
    buffer_load_dwordx4 v[224:227], v16, s[20:23], s51 offen
    buffer_load_dwordx2 v[236:237], v14, s[20:23], s56 offen
    s_mov_b32 s16, s4
    s_and_b32 s17, s5, 0xffff
    s_mov_b32 s18, 5120000
    s_mov_b32 s19, 0x00020000
    s_barrier
    s_mul_i32 s53, s2, 40
    s_mul_i32 s52, s36, 5
    s_add_u32 s53, s53, s52
    s_lshl_b32 s52, s53, 9
    v_min_u32 v17, 4, v1
    v_lshlrev_b32 v17, 9, v17
    v_lshl_add_u32 v17, v2, 4, v17
    buffer_load_dwordx4 v[160:163], v17, s[16:19], s52 offen offset:0
    buffer_load_dwordx4 v[164:167], v17, s[16:19], s52 offen offset:64
    buffer_load_dwordx4 v[168:171], v17, s[16:19], s52 offen offset:128
    buffer_load_dwordx4 v[172:175], v17, s[16:19], s52 offen offset:192
    buffer_load_dwordx4 v[176:179], v17, s[16:19], s52 offen offset:256
    buffer_load_dwordx4 v[180:183], v17, s[16:19], s52 offen offset:320
    buffer_load_dwordx4 v[184:187], v17, s[16:19], s52 offen offset:384
    buffer_load_dwordx4 v[188:191], v17, s[16:19], s52 offen offset:448
    s_mul_i32 s47, s36, 17056
    s_add_u32 s47, s47, 23808
    s_add_u32 s51, s47, 8448
    s_xor_b32 s46, s47, s51
    v_and_b32 v16, 7, v1
    v_mul_u32_u24 v4, 1056, v16
    v_lshrrev_b32 v16, 3, v1
    v_lshl_add_u32 v4, v16, 9, v4
    v_lshl_add_u32 v4, v2, 4, v4
    v_bfe_u32 v16, v3, 2, 3
    v_mul_u32_u24 v5, 1056, v16
    v_lshrrev_b32 v16, 5, v3
    v_lshl_add_u32 v5, v16, 9, v5
    v_lshlrev_b32 v9, 5, v16
    v_and_b32 v16, 3, v3
    v_lshl_add_u32 v5, v16, 3, v5
    v_lshlrev_b32 v8, 4, v2
    v_and_b32 v16, 31, v3
    v_lshlrev_b32 v10, 4, v16
    v_lshlrev_b32 v13, 4, v3
    s_lshl_b32 s51, s36, 16
    s_add_u32 s82, s51, 2097152
    s_mov_b32 s50, 0xfffffe00
    v_mov_b32 v20, 0x3f803f80
    v_mov_b32 v21, 0x3f803f80
    s_lshl_b32 s37, s36, 11
    s_add_u32 s37, s37, 6400
    s_mov_b32 s43, 0
    s_mov_b32 s49, 0
    s_mov_b32 s60, 1
    v_cmp_gt_u32 s[80:81], 12, v1
    v_cmp_gt_u32 s[14:15], 8, v1
    v_mov_b32 v16, 1
    s_waitcnt vmcnt(9)
    v_cmp_ne_u32 s[64:65], s62, v224
    v_bfe_u32 v96, v224, 3, 5
    v_lshlrev_b32 v96, 2, v96
    v_cmp_ne_u32 s[66:67], s62, v225
    v_bfe_u32 v97, v225, 3, 5
    v_lshlrev_b32 v97, 2, v97
    v_cmp_ne_u32 s[68:69], s62, v226
    v_bfe_u32 v98, v226, 3, 5
    v_lshlrev_b32 v98, 2, v98
    v_cmp_ne_u32 s[70:71], s62, v227
    v_bfe_u32 v99, v227, 3, 5
    v_lshlrev_b32 v99, 2, v99
    s_mov_b64 exec, s[64:65]
    ds_add_rtn_u32 v100, v96, v16 offset:0
    s_mov_b64 exec, s[66:67]
    ds_add_rtn_u32 v101, v97, v16 offset:0
    s_mov_b64 exec, s[68:69]
    ds_add_rtn_u32 v102, v98, v16 offset:0
    s_mov_b64 exec, s[70:71]
    ds_add_rtn_u32 v103, v99, v16 offset:0
    s_mov_b64 exec, -1
    v_min_u32 v96, 64, v96
    v_min_u32 v97, 64, v97
    v_min_u32 v98, 64, v98
    v_min_u32 v99, 64, v99
    s_waitcnt vmcnt(8)
    ds_write_b64 v14, v[236:237] offset:2304
    s_waitcnt lgkmcnt(1)
    v_min_u32 v100, 255, v100
    v_lshlrev_b32 v100, 2, v100
    v_lshl_add_u32 v100, v96, 8, v100
    v_min_u32 v101, 255, v101
    v_lshlrev_b32 v101, 2, v101
    v_lshl_add_u32 v101, v97, 8, v101
    v_min_u32 v102, 255, v102
    v_lshlrev_b32 v102, 2, v102
    v_lshl_add_u32 v102, v98, 8, v102
    v_min_u32 v103, 255, v103
    v_lshlrev_b32 v103, 2, v103
    v_lshl_add_u32 v103, v99, 8, v103
    s_mov_b64 exec, s[64:65]
    ds_write_b32 v100, v224 offset:6400
    s_mov_b64 exec, s[66:67]
    ds_write_b32 v101, v225 offset:6400
    s_mov_b64 exec, s[68:69]
    ds_write_b32 v102, v226 offset:6400
    s_mov_b64 exec, s[70:71]
    ds_write_b32 v103, v227 offset:6400
    s_mov_b64 exec, -1
    v_and_b32 v17, 31, v3
    v_lshlrev_b32 v15, 2, v17
    v_mov_b32 v14, 256
    v_cmp_eq_u32 vcc, 30, v17
    v_cmp_gt_u32 s[64:65], 16, v17
    s_lshl_b32 s51, s36, 1
    v_cndmask_b32 v14, v14, 0, vcc
    s_or_b64 s[64:65], s[64:65], vcc
    s_add_u32 s52, s51, 1
    v_add_u32 v17, s37, v9
    s_waitcnt lgkmcnt(0)
    s_barrier
    ds_read_b32 v16, v15 offset:0
    ds_read_b128 v[224:227], v17 offset:0
    ds_read_b128 v[228:231], v17 offset:16
    s_waitcnt lgkmcnt(2)
    v_cmp_gt_u32 vcc, v16, v14
    v_readlane_b32 s38, v16, s51
    v_readlane_b32 s39, v16, s52
    s_and_b64 vcc, vcc, s[64:65]
    s_cbranch_vccnz K3_SLOW
    s_add_u32 s38, s38, 15
    s_lshr_b32 s38, s38, 4
    s_max_u32 s38, s38, 1
    s_add_u32 s39, s39, 15
    s_lshr_b32 s39, s39, 4
    s_max_u32 s39, s39, 1
    s_mov_b32 s41, s37
    s_mov_b32 s42, s38
    s_mov_b32 s44, s37
    s_add_u32 s45, s38, s39
    s_waitcnt lgkmcnt(0)
    s_mov_b32 m0, s47
    v_and_or_b32 v224, v224, s50, v10
    buffer_load_dwordx4 v224, s[16:19], 0 offen lds
    s_add_u32 m0, m0, 1056
    v_and_or_b32 v225, v225, s50, v10
    buffer_load_dwordx4 v225, s[16:19], 0 offen lds
    s_add_u32 m0, m0, 1056
    v_and_or_b32 v226, v226, s50, v10
    buffer_load_dwordx4 v226, s[16:19], 0 offen lds
    s_add_u32 m0, m0, 1056
    v_and_or_b32 v227, v227, s50, v10
    buffer_load_dwordx4 v227, s[16:19], 0 offen lds
    s_add_u32 m0, m0, 1056
    v_and_or_b32 v228, v228, s50, v10
    buffer_load_dwordx4 v228, s[16:19], 0 offen lds
    s_add_u32 m0, m0, 1056
    v_and_or_b32 v229, v229, s50, v10
    buffer_load_dwordx4 v229, s[16:19], 0 offen lds
    s_add_u32 m0, m0, 1056
    v_and_or_b32 v230, v230, s50, v10
    buffer_load_dwordx4 v230, s[16:19], 0 offen lds
    s_add_u32 m0, m0, 1056
    v_and_or_b32 v231, v231, s50, v10
    buffer_load_dwordx4 v231, s[16:19], 0 offen lds
    s_add_u32 s44, s44, 64
    s_sub_u32 s45, s45, 1
    s_add_u32 s51, s37, 1024
    s_cmp_eq_u32 s45, s39
    s_cselect_b32 s44, s51, s44
    v_add_u32 v17, s44, v9
    ds_read_b128 v[224:227], v17 offset:0
    ds_read_b128 v[228:231], v17 offset:16
    s_xor_b32 s52, s47, s46
    s_waitcnt lgkmcnt(0)
    v_and_b32 v14, 3, v1
    v_lshlrev_b32 v15, 9, v14
    v_lshl_add_u32 v15, v2, 4, v15
    ds_read_b128 v[192:195], v15 offset:4352
    ds_read_b128 v[196:199], v15 offset:4416
    ds_read_b128 v[200:203], v15 offset:4480
    ds_read_b128 v[204:207], v15 offset:4544
    ds_read_b128 v[208:211], v15 offset:4608
    ds_read_b128 v[212:215], v15 offset:4672
    ds_read_b128 v[216:219], v15 offset:4736
    ds_read_b128 v[220:223], v15 offset:4800
    ds_read_b128 v[128:131], v15 offset:2304
    ds_read_b128 v[132:135], v15 offset:2368
    ds_read_b128 v[136:139], v15 offset:2432
    ds_read_b128 v[140:143], v15 offset:2496
    ds_read_b128 v[144:147], v15 offset:2560
    ds_read_b128 v[148:151], v15 offset:2624
    ds_read_b128 v[152:155], v15 offset:2688
    ds_read_b128 v[156:159], v15 offset:2752
    s_mov_b32 m0, s52
    v_and_or_b32 v224, v224, s50, v10
    buffer_load_dwordx4 v224, s[16:19], 0 offen lds
    s_lshl_b32 s51, s36, 8
    v_lshlrev_b32 v14, 6, v14
    v_add_u32 v14, s51, v14
    v_lshl_add_u32 v15, v2, 4, v14
    s_add_u32 m0, m0, 1056
    v_and_or_b32 v225, v225, s50, v10
    buffer_load_dwordx4 v225, s[16:19], 0 offen lds
    v_lshrrev_b32 v11, 2, v1
    v_lshl_add_u32 v14, v11, 2, v14
    v_cmp_gt_u32 s[64:65], 4, v1
    s_lshl_b32 s51, s36, 4
    v_add_u32 v11, s51, v11
    s_add_u32 m0, m0, 1056
    v_and_or_b32 v226, v226, s50, v10
    buffer_load_dwordx4 v226, s[16:19], 0 offen lds
    s_waitcnt vmcnt(11) lgkmcnt(8)
    v_mfma_f32_16x16x32_bf16 v[236:239], v[160:163], v[192:195], 0
    v_mfma_f32_16x16x32_bf16 v[236:239], v[164:167], v[196:199], v[236:239]
    s_add_u32 m0, m0, 1056
    v_and_or_b32 v227, v227, s50, v10
    buffer_load_dwordx4 v227, s[16:19], 0 offen lds
    v_mfma_f32_16x16x32_bf16 v[236:239], v[168:171], v[200:203], v[236:239]
    v_mfma_f32_16x16x32_bf16 v[236:239], v[172:175], v[204:207], v[236:239]
    s_add_u32 m0, m0, 1056
    v_and_or_b32 v228, v228, s50, v10
    buffer_load_dwordx4 v228, s[16:19], 0 offen lds
    v_mfma_f32_16x16x32_bf16 v[236:239], v[176:179], v[208:211], v[236:239]
    v_mfma_f32_16x16x32_bf16 v[236:239], v[180:183], v[212:215], v[236:239]
    s_add_u32 m0, m0, 1056
    v_and_or_b32 v229, v229, s50, v10
    buffer_load_dwordx4 v229, s[16:19], 0 offen lds
    v_mfma_f32_16x16x32_bf16 v[236:239], v[184:187], v[216:219], v[236:239]
    v_mfma_f32_16x16x32_bf16 v[236:239], v[188:191], v[220:223], v[236:239]
    s_add_u32 m0, m0, 1056
    v_and_or_b32 v230, v230, s50, v10
    buffer_load_dwordx4 v230, s[16:19], 0 offen lds
    s_add_u32 m0, m0, 1056
    v_and_or_b32 v231, v231, s50, v10
    buffer_load_dwordx4 v231, s[16:19], 0 offen lds
    s_nop 7
    s_mov_b64 exec, s[64:65]
    ds_write_b128 v15, v[236:239] offset:256
    s_mov_b64 exec, -1
    ds_read_b32 v24, v14 offset:256
    ds_read_b32 v12, v14 offset:268
    s_waitcnt lgkmcnt(0)
    v_mov_b32 v25, v24
    v_mov_b32 v26, v24
    v_mov_b32 v27, v24
    s_add_u32 s44, s44, 64
    s_sub_u32 s45, s45, 1
    s_add_u32 s51, s37, 1024
    s_cmp_eq_u32 s45, s39
    s_cselect_b32 s44, s51, s44
    s_mov_b32 s48, 2
K3_LOOP:
    s_cmp_ge_u32 s48, 2
    s_cbranch_scc1 K3_W8
    s_waitcnt vmcnt(0)
K3_W8:
    s_waitcnt vmcnt(8)
    v_add_u32 v6, s47, v4
    v_add_u32 v7, s47, v5
    v_add_u32 v16, s41, v8
    ds_read_b128 v[160:163], v6 offset:0
    ds_read_b128 v[164:167], v6 offset:64
    ds_read_b128 v[168:171], v6 offset:128
    ds_read_b128 v[172:175], v6 offset:192
    ds_read_b128 v[176:179], v6 offset:256
    ds_read_b128 v[180:183], v6 offset:320
    ds_read_b128 v[184:187], v6 offset:384
    ds_read_b128 v[188:191], v6 offset:448
    ds_read_b128 v[232:235], v16
    v_add_u32 v17, s44, v9
    ds_read_b128 v[224:227], v17 offset:0
    ds_read_b128 v[228:231], v17 offset:16
    ds_read_b64_tr_b16 v[192:193], v7 offset:0
    ds_read_b64_tr_b16 v[194:195], v7 offset:32
    ds_read_b64_tr_b16 v[196:197], v7 offset:64
    ds_read_b64_tr_b16 v[198:199], v7 offset:96
    ds_read_b64_tr_b16 v[200:201], v7 offset:128
    ds_read_b64_tr_b16 v[202:203], v7 offset:160
    ds_read_b64_tr_b16 v[204:205], v7 offset:192
    ds_read_b64_tr_b16 v[206:207], v7 offset:224
    ds_read_b64_tr_b16 v[208:209], v7 offset:256
    ds_read_b64_tr_b16 v[210:211], v7 offset:288
    ds_read_b64_tr_b16 v[212:213], v7 offset:320
    ds_read_b64_tr_b16 v[214:215], v7 offset:352
    ds_read_b64_tr_b16 v[216:217], v7 offset:384
    ds_read_b64_tr_b16 v[218:219], v7 offset:416
    ds_read_b64_tr_b16 v[220:221], v7 offset:448
    ds_read_b64_tr_b16 v[222:223], v7 offset:480
    s_waitcnt lgkmcnt(15)
    v_mfma_f32_16x16x32_bf16 v[236:239], v[160:163], v[128:131], v[24:27]
    v_mfma_f32_16x16x32_bf16 v[236:239], v[164:167], v[132:135], v[236:239]
    v_mfma_f32_16x16x32_bf16 v[236:239], v[168:171], v[136:139], v[236:239]
    v_mfma_f32_16x16x32_bf16 v[236:239], v[172:175], v[140:143], v[236:239]
    v_mfma_f32_16x16x32_bf16 v[236:239], v[176:179], v[144:147], v[236:239]
    v_mfma_f32_16x16x32_bf16 v[236:239], v[180:183], v[148:151], v[236:239]
    v_mfma_f32_16x16x32_bf16 v[236:239], v[184:187], v[152:155], v[236:239]
    v_mfma_f32_16x16x32_bf16 v[236:239], v[188:191], v[156:159], v[236:239]
    v_cmp_eq_u32_sdwa s[64:65], v232, v11 src0_sel:BYTE_0 src1_sel:DWORD
    v_cmp_eq_u32_sdwa s[66:67], v233, v11 src0_sel:BYTE_0 src1_sel:DWORD
    v_cmp_eq_u32_sdwa s[68:69], v234, v11 src0_sel:BYTE_0 src1_sel:DWORD
    v_cmp_eq_u32_sdwa s[70:71], v235, v11 src0_sel:BYTE_0 src1_sel:DWORD
    s_waitcnt lgkmcnt(0)
    s_cmp_eq_u32 s45, 0
    s_cbranch_scc1 PT_1_N
    s_cmp_eq_u32 s60, 1
    s_cbranch_scc1 PT_1_DF
    s_mov_b32 m0, s47
    v_and_or_b32 v224, v224, s50, v10
    buffer_load_dwordx4 v224, s[16:19], 0 offen lds
    v_mul_f32 v240, 0x3e4ccccd, v236
    v_mul_f32 v241, 0x3e4ccccd, v237
    v_mul_f32 v242, 0x3e4ccccd, v238
    v_mul_f32 v243, 0x3e4ccccd, v239
    v_max_f32 v240, v236, v240
    v_max_f32 v241, v237, v241
    s_add_u32 m0, m0, 1056
    v_and_or_b32 v225, v225, s50, v10
    buffer_load_dwordx4 v225, s[16:19], 0 offen lds
    v_max_f32 v242, v238, v242
    v_max_f32 v243, v239, v243
    v_exp_f32 v240, v240
    v_exp_f32 v241, v241
    v_exp_f32 v242, v242
    v_exp_f32 v243, v243
    s_add_u32 m0, m0, 1056
    v_and_or_b32 v226, v226, s50, v10
    buffer_load_dwordx4 v226, s[16:19], 0 offen lds
    v_cndmask_b32 v240, 0, v240, s[64:65]
    v_cndmask_b32 v241, 0, v241, s[66:67]
    v_cndmask_b32 v242, 0, v242, s[68:69]
    v_cndmask_b32 v243, 0, v243, s[70:71]
    v_cvt_pk_bf16_f32 v18, v240, v241
    v_cvt_pk_bf16_f32 v19, v242, v243
    s_nop 1
    s_add_u32 m0, m0, 1056
    v_and_or_b32 v227, v227, s50, v10
    buffer_load_dwordx4 v227, s[16:19], 0 offen lds
    v_mfma_f32_16x16x16_bf16 v[28:31], v[20:21], v[18:19], v[28:31]
    v_mfma_f32_16x16x16_bf16 v[32:35], v[192:193], v[18:19], v[32:35]
    v_mfma_f32_16x16x16_bf16 v[36:39], v[194:195], v[18:19], v[36:39]
    s_add_u32 m0, m0, 1056
    v_and_or_b32 v228, v228, s50, v10
    buffer_load_dwordx4 v228, s[16:19], 0 offen lds
    v_mfma_f32_16x16x16_bf16 v[40:43], v[196:197], v[18:19], v[40:43]
    v_mfma_f32_16x16x16_bf16 v[44:47], v[198:199], v[18:19], v[44:47]
    v_mfma_f32_16x16x16_bf16 v[48:51], v[200:201], v[18:19], v[48:51]
    s_add_u32 m0, m0, 1056
    v_and_or_b32 v229, v229, s50, v10
    buffer_load_dwordx4 v229, s[16:19], 0 offen lds
    v_mfma_f32_16x16x16_bf16 v[52:55], v[202:203], v[18:19], v[52:55]
    v_mfma_f32_16x16x16_bf16 v[56:59], v[204:205], v[18:19], v[56:59]
    v_mfma_f32_16x16x16_bf16 v[60:63], v[206:207], v[18:19], v[60:63]
    s_add_u32 m0, m0, 1056
    v_and_or_b32 v230, v230, s50, v10
    buffer_load_dwordx4 v230, s[16:19], 0 offen lds
    v_mfma_f32_16x16x16_bf16 v[64:67], v[208:209], v[18:19], v[64:67]
    v_mfma_f32_16x16x16_bf16 v[68:71], v[210:211], v[18:19], v[68:71]
    v_mfma_f32_16x16x16_bf16 v[72:75], v[212:213], v[18:19], v[72:75]
    s_add_u32 m0, m0, 1056
    v_and_or_b32 v231, v231, s50, v10
    buffer_load_dwordx4 v231, s[16:19], 0 offen lds
    v_mfma_f32_16x16x16_bf16 v[76:79], v[214:215], v[18:19], v[76:79]
    v_mfma_f32_16x16x16_bf16 v[80:83], v[216:217], v[18:19], v[80:83]
    v_mfma_f32_16x16x16_bf16 v[84:87], v[218:219], v[18:19], v[84:87]
    v_mfma_f32_16x16x16_bf16 v[88:91], v[220:221], v[18:19], v[88:91]
    v_mfma_f32_16x16x16_bf16 v[92:95], v[222:223], v[18:19], v[92:95]
    s_branch PT_1_A
PT_1_DF:
    s_mov_b32 m0, s47
    v_and_or_b32 v224, v224, s50, v10
    buffer_load_dwordx4 v224, s[16:19], 0 offen lds
    v_mul_f32 v240, 0x3e4ccccd, v236
    v_mul_f32 v241, 0x3e4ccccd, v237
    v_mul_f32 v242, 0x3e4ccccd, v238
    v_mul_f32 v243, 0x3e4ccccd, v239
    v_max_f32 v240, v236, v240
    v_max_f32 v241, v237, v241
    s_add_u32 m0, m0, 1056
    v_and_or_b32 v225, v225, s50, v10
    buffer_load_dwordx4 v225, s[16:19], 0 offen lds
    v_max_f32 v242, v238, v242
    v_max_f32 v243, v239, v243
    v_exp_f32 v240, v240
    v_exp_f32 v241, v241
    v_exp_f32 v242, v242
    v_exp_f32 v243, v243
    s_add_u32 m0, m0, 1056
    v_and_or_b32 v226, v226, s50, v10
    buffer_load_dwordx4 v226, s[16:19], 0 offen lds
    v_cndmask_b32 v240, 0, v240, s[64:65]
    v_cndmask_b32 v241, 0, v241, s[66:67]
    v_cndmask_b32 v242, 0, v242, s[68:69]
    v_cndmask_b32 v243, 0, v243, s[70:71]
    v_cvt_pk_bf16_f32 v18, v240, v241
    v_cvt_pk_bf16_f32 v19, v242, v243
    s_nop 1
    s_add_u32 m0, m0, 1056
    v_and_or_b32 v227, v227, s50, v10
    buffer_load_dwordx4 v227, s[16:19], 0 offen lds
    v_mfma_f32_16x16x16_bf16 v[28:31], v[20:21], v[18:19], 0
    v_mfma_f32_16x16x16_bf16 v[32:35], v[192:193], v[18:19], 0
    v_mfma_f32_16x16x16_bf16 v[36:39], v[194:195], v[18:19], 0
    s_add_u32 m0, m0, 1056
    v_and_or_b32 v228, v228, s50, v10
    buffer_load_dwordx4 v228, s[16:19], 0 offen lds
    v_mfma_f32_16x16x16_bf16 v[40:43], v[196:197], v[18:19], 0
    v_mfma_f32_16x16x16_bf16 v[44:47], v[198:199], v[18:19], 0
    v_mfma_f32_16x16x16_bf16 v[48:51], v[200:201], v[18:19], 0
    s_add_u32 m0, m0, 1056
    v_and_or_b32 v229, v229, s50, v10
    buffer_load_dwordx4 v229, s[16:19], 0 offen lds
    v_mfma_f32_16x16x16_bf16 v[52:55], v[202:203], v[18:19], 0
    v_mfma_f32_16x16x16_bf16 v[56:59], v[204:205], v[18:19], 0
    v_mfma_f32_16x16x16_bf16 v[60:63], v[206:207], v[18:19], 0
    s_add_u32 m0, m0, 1056
    v_and_or_b32 v230, v230, s50, v10
    buffer_load_dwordx4 v230, s[16:19], 0 offen lds
    v_mfma_f32_16x16x16_bf16 v[64:67], v[208:209], v[18:19], 0
    v_mfma_f32_16x16x16_bf16 v[68:71], v[210:211], v[18:19], 0
    v_mfma_f32_16x16x16_bf16 v[72:75], v[212:213], v[18:19], 0
    s_add_u32 m0, m0, 1056
    v_and_or_b32 v231, v231, s50, v10
    buffer_load_dwordx4 v231, s[16:19], 0 offen lds
    v_mfma_f32_16x16x16_bf16 v[76:79], v[214:215], v[18:19], 0
    v_mfma_f32_16x16x16_bf16 v[80:83], v[216:217], v[18:19], 0
    v_mfma_f32_16x16x16_bf16 v[84:87], v[218:219], v[18:19], 0
    v_mfma_f32_16x16x16_bf16 v[88:91], v[220:221], v[18:19], 0
    v_mfma_f32_16x16x16_bf16 v[92:95], v[222:223], v[18:19], 0
PT_1_A:
    s_add_u32 s44, s44, 64
    s_sub_u32 s45, s45, 1
    s_add_u32 s51, s37, 1024
    s_cmp_eq_u32 s45, s39
    s_cselect_b32 s44, s51, s44
    s_add_u32 s48, s48, 1
    s_branch PT_1_E
PT_1_N:
    s_cmp_eq_u32 s60, 1
    s_cbranch_scc1 PT_1_NF
    s_nop 3
    v_mul_f32 v240, 0x3e4ccccd, v236
    v_mul_f32 v241, 0x3e4ccccd, v237
    v_mul_f32 v242, 0x3e4ccccd, v238
    v_mul_f32 v243, 0x3e4ccccd, v239
    v_max_f32 v240, v236, v240
    v_max_f32 v241, v237, v241
    v_max_f32 v242, v238, v242
    v_max_f32 v243, v239, v243
    v_exp_f32 v240, v240
    v_exp_f32 v241, v241
    v_exp_f32 v242, v242
    v_exp_f32 v243, v243
    v_cndmask_b32 v240, 0, v240, s[64:65]
    v_cndmask_b32 v241, 0, v241, s[66:67]
    v_cndmask_b32 v242, 0, v242, s[68:69]
    v_cndmask_b32 v243, 0, v243, s[70:71]
    v_cvt_pk_bf16_f32 v18, v240, v241
    v_cvt_pk_bf16_f32 v19, v242, v243
    s_nop 1
    v_mfma_f32_16x16x16_bf16 v[28:31], v[20:21], v[18:19], v[28:31]
    v_mfma_f32_16x16x16_bf16 v[32:35], v[192:193], v[18:19], v[32:35]
    v_mfma_f32_16x16x16_bf16 v[36:39], v[194:195], v[18:19], v[36:39]
    v_mfma_f32_16x16x16_bf16 v[40:43], v[196:197], v[18:19], v[40:43]
    v_mfma_f32_16x16x16_bf16 v[44:47], v[198:199], v[18:19], v[44:47]
    v_mfma_f32_16x16x16_bf16 v[48:51], v[200:201], v[18:19], v[48:51]
    v_mfma_f32_16x16x16_bf16 v[52:55], v[202:203], v[18:19], v[52:55]
    v_mfma_f32_16x16x16_bf16 v[56:59], v[204:205], v[18:19], v[56:59]
    v_mfma_f32_16x16x16_bf16 v[60:63], v[206:207], v[18:19], v[60:63]
    v_mfma_f32_16x16x16_bf16 v[64:67], v[208:209], v[18:19], v[64:67]
    v_mfma_f32_16x16x16_bf16 v[68:71], v[210:211], v[18:19], v[68:71]
    v_mfma_f32_16x16x16_bf16 v[72:75], v[212:213], v[18:19], v[72:75]
    v_mfma_f32_16x16x16_bf16 v[76:79], v[214:215], v[18:19], v[76:79]
    v_mfma_f32_16x16x16_bf16 v[80:83], v[216:217], v[18:19], v[80:83]
    v_mfma_f32_16x16x16_bf16 v[84:87], v[218:219], v[18:19], v[84:87]
    v_mfma_f32_16x16x16_bf16 v[88:91], v[220:221], v[18:19], v[88:91]
    v_mfma_f32_16x16x16_bf16 v[92:95], v[222:223], v[18:19], v[92:95]
    s_branch PT_1_E
PT_1_NF:
    s_nop 3
    v_mul_f32 v240, 0x3e4ccccd, v236
    v_mul_f32 v241, 0x3e4ccccd, v237
    v_mul_f32 v242, 0x3e4ccccd, v238
    v_mul_f32 v243, 0x3e4ccccd, v239
    v_max_f32 v240, v236, v240
    v_max_f32 v241, v237, v241
    v_max_f32 v242, v238, v242
    v_max_f32 v243, v239, v243
    v_exp_f32 v240, v240
    v_exp_f32 v241, v241
    v_exp_f32 v242, v242
    v_exp_f32 v243, v243
    v_cndmask_b32 v240, 0, v240, s[64:65]
    v_cndmask_b32 v241, 0, v241, s[66:67]
    v_cndmask_b32 v242, 0, v242, s[68:69]
    v_cndmask_b32 v243, 0, v243, s[70:71]
    v_cvt_pk_bf16_f32 v18, v240, v241
    v_cvt_pk_bf16_f32 v19, v242, v243
    s_nop 1
    v_mfma_f32_16x16x16_bf16 v[28:31], v[20:21], v[18:19], 0
    v_mfma_f32_16x16x16_bf16 v[32:35], v[192:193], v[18:19], 0
    v_mfma_f32_16x16x16_bf16 v[36:39], v[194:195], v[18:19], 0
    v_mfma_f32_16x16x16_bf16 v[40:43], v[196:197], v[18:19], 0
    v_mfma_f32_16x16x16_bf16 v[44:47], v[198:199], v[18:19], 0
    v_mfma_f32_16x16x16_bf16 v[48:51], v[200:201], v[18:19], 0
    v_mfma_f32_16x16x16_bf16 v[52:55], v[202:203], v[18:19], 0
    v_mfma_f32_16x16x16_bf16 v[56:59], v[204:205], v[18:19], 0
    v_mfma_f32_16x16x16_bf16 v[60:63], v[206:207], v[18:19], 0
    v_mfma_f32_16x16x16_bf16 v[64:67], v[208:209], v[18:19], 0
    v_mfma_f32_16x16x16_bf16 v[68:71], v[210:211], v[18:19], 0
    v_mfma_f32_16x16x16_bf16 v[72:75], v[212:213], v[18:19], 0
    v_mfma_f32_16x16x16_bf16 v[76:79], v[214:215], v[18:19], 0
    v_mfma_f32_16x16x16_bf16 v[80:83], v[216:217], v[18:19], 0
    v_mfma_f32_16x16x16_bf16 v[84:87], v[218:219], v[18:19], 0
    v_mfma_f32_16x16x16_bf16 v[88:91], v[220:221], v[18:19], 0
    v_mfma_f32_16x16x16_bf16 v[92:95], v[222:223], v[18:19], 0
PT_1_E:
    s_mov_b32 s60, 0
    s_sub_u32 s48, s48, 1
    s_xor_b32 s47, s47, s46
    s_add_u32 s41, s41, 64
    s_sub_u32 s42, s42, 1
    s_cmp_lg_u32 s42, 0
    s_cbranch_scc1 K3_LOOP
K3_FIN:
    s_cmp_eq_u32 s43, 1
    s_cbranch_scc1 K3_F1
K3_F0:
    v_add_f32 v16, 0x3089705f, v28
    v_rcp_f32 v16, v16
    s_nop 0
    v_mul_f32 v16, 0.25, v16
    v_mov_b32 v24, v12
    v_mov_b32 v25, v12
    v_mov_b32 v26, v12
    v_mov_b32 v27, v12
    v_add_u32 v11, 8, v11
    s_mov_b32 s43, 1
    s_add_u32 s41, s37, 1024
    s_mov_b32 s42, s39
    s_mov_b32 s60, 1
    v_pk_mul_f32 v[32:33], v[32:33], v[16:17] op_sel_hi:[1,0]
    v_pk_mul_f32 v[34:35], v[34:35], v[16:17] op_sel_hi:[1,0]
    v_cvt_pk_bf16_f32 v96, v32, v33
    v_cvt_pk_bf16_f32 v97, v34, v35
    v_pk_mul_f32 v[36:37], v[36:37], v[16:17] op_sel_hi:[1,0]
    v_pk_mul_f32 v[38:39], v[38:39], v[16:17] op_sel_hi:[1,0]
    v_cvt_pk_bf16_f32 v98, v36, v37
    v_cvt_pk_bf16_f32 v99, v38, v39
    v_pk_mul_f32 v[40:41], v[40:41], v[16:17] op_sel_hi:[1,0]
    v_pk_mul_f32 v[42:43], v[42:43], v[16:17] op_sel_hi:[1,0]
    v_cvt_pk_bf16_f32 v100, v40, v41
    v_cvt_pk_bf16_f32 v101, v42, v43
    v_pk_mul_f32 v[44:45], v[44:45], v[16:17] op_sel_hi:[1,0]
    v_pk_mul_f32 v[46:47], v[46:47], v[16:17] op_sel_hi:[1,0]
    v_cvt_pk_bf16_f32 v102, v44, v45
    v_cvt_pk_bf16_f32 v103, v46, v47
    v_pk_mul_f32 v[48:49], v[48:49], v[16:17] op_sel_hi:[1,0]
    v_pk_mul_f32 v[50:51], v[50:51], v[16:17] op_sel_hi:[1,0]
    v_cvt_pk_bf16_f32 v104, v48, v49
    v_cvt_pk_bf16_f32 v105, v50, v51
    v_pk_mul_f32 v[52:53], v[52:53], v[16:17] op_sel_hi:[1,0]
    v_pk_mul_f32 v[54:55], v[54:55], v[16:17] op_sel_hi:[1,0]
    v_cvt_pk_bf16_f32 v106, v52, v53
    v_cvt_pk_bf16_f32 v107, v54, v55
    v_pk_mul_f32 v[56:57], v[56:57], v[16:17] op_sel_hi:[1,0]
    v_pk_mul_f32 v[58:59], v[58:59], v[16:17] op_sel_hi:[1,0]
    v_cvt_pk_bf16_f32 v108, v56, v57
    v_cvt_pk_bf16_f32 v109, v58, v59
    v_pk_mul_f32 v[60:61], v[60:61], v[16:17] op_sel_hi:[1,0]
    v_pk_mul_f32 v[62:63], v[62:63], v[16:17] op_sel_hi:[1,0]
    v_cvt_pk_bf16_f32 v110, v60, v61
    v_cvt_pk_bf16_f32 v111, v62, v63
    v_pk_mul_f32 v[64:65], v[64:65], v[16:17] op_sel_hi:[1,0]
    v_pk_mul_f32 v[66:67], v[66:67], v[16:17] op_sel_hi:[1,0]
    v_cvt_pk_bf16_f32 v112, v64, v65
    v_cvt_pk_bf16_f32 v113, v66, v67
    v_pk_mul_f32 v[68:69], v[68:69], v[16:17] op_sel_hi:[1,0]
    v_pk_mul_f32 v[70:71], v[70:71], v[16:17] op_sel_hi:[1,0]
    v_cvt_pk_bf16_f32 v114, v68, v69
    v_cvt_pk_bf16_f32 v115, v70, v71
    v_pk_mul_f32 v[72:73], v[72:73], v[16:17] op_sel_hi:[1,0]
    v_pk_mul_f32 v[74:75], v[74:75], v[16:17] op_sel_hi:[1,0]
    v_cvt_pk_bf16_f32 v116, v72, v73
    v_cvt_pk_bf16_f32 v117, v74, v75
    v_pk_mul_f32 v[76:77], v[76:77], v[16:17] op_sel_hi:[1,0]
    v_pk_mul_f32 v[78:79], v[78:79], v[16:17] op_sel_hi:[1,0]
    v_cvt_pk_bf16_f32 v118, v76, v77
    v_cvt_pk_bf16_f32 v119, v78, v79
    v_pk_mul_f32 v[80:81], v[80:81], v[16:17] op_sel_hi:[1,0]
    v_pk_mul_f32 v[82:83], v[82:83], v[16:17] op_sel_hi:[1,0]
    v_cvt_pk_bf16_f32 v120, v80, v81
    v_cvt_pk_bf16_f32 v121, v82, v83
    v_pk_mul_f32 v[84:85], v[84:85], v[16:17] op_sel_hi:[1,0]
    v_pk_mul_f32 v[86:87], v[86:87], v[16:17] op_sel_hi:[1,0]
    v_cvt_pk_bf16_f32 v122, v84, v85
    v_cvt_pk_bf16_f32 v123, v86, v87
    v_pk_mul_f32 v[88:89], v[88:89], v[16:17] op_sel_hi:[1,0]
    v_pk_mul_f32 v[90:91], v[90:91], v[16:17] op_sel_hi:[1,0]
    v_cvt_pk_bf16_f32 v124, v88, v89
    v_cvt_pk_bf16_f32 v125, v90, v91
    v_pk_mul_f32 v[92:93], v[92:93], v[16:17] op_sel_hi:[1,0]
    v_pk_mul_f32 v[94:95], v[94:95], v[16:17] op_sel_hi:[1,0]
    v_cvt_pk_bf16_f32 v126, v92, v93
    v_cvt_pk_bf16_f32 v127, v94, v95
    s_cmp_eq_u32 s49, 0
    s_cbranch_scc1 K3_LOOP
    s_branch K3_SLOW_SUB
K3_F1:
    s_add_u32 s63, s82, 0
    buffer_load_dwordx4 v[160:163], v13, s[20:23], s63 offen offset:0
    buffer_load_dwordx4 v[164:167], v13, s[20:23], s63 offen offset:1024
    buffer_load_dwordx4 v[168:171], v13, s[20:23], s63 offen offset:2048
    buffer_load_dwordx4 v[172:175], v13, s[20:23], s63 offen offset:3072
    s_add_u32 s63, s82, 4096
    buffer_load_dwordx4 v[176:179], v13, s[20:23], s63 offen offset:0
    buffer_load_dwordx4 v[180:183], v13, s[20:23], s63 offen offset:1024
    buffer_load_dwordx4 v[184:187], v13, s[20:23], s63 offen offset:2048
    buffer_load_dwordx4 v[188:191], v13, s[20:23], s63 offen offset:3072
    s_add_u32 s63, s82, 8192
    buffer_load_dwordx4 v[192:195], v13, s[20:23], s63 offen offset:0
    buffer_load_dwordx4 v[196:199], v13, s[20:23], s63 offen offset:1024
    buffer_load_dwordx4 v[200:203], v13, s[20:23], s63 offen offset:2048
    buffer_load_dwordx4 v[204:207], v13, s[20:23], s63 offen offset:3072
    s_add_u32 s63, s82, 12288
    buffer_load_dwordx4 v[208:211], v13, s[20:23], s63 offen offset:0
    buffer_load_dwordx4 v[212:215], v13, s[20:23], s63 offen offset:1024
    buffer_load_dwordx4 v[216:219], v13, s[20:23], s63 offen offset:2048
    buffer_load_dwordx4 v[220:223], v13, s[20:23], s63 offen offset:3072
    s_add_u32 s63, s82, 16384
    buffer_load_dwordx4 v[128:131], v13, s[20:23], s63 offen offset:0
    buffer_load_dwordx4 v[132:135], v13, s[20:23], s63 offen offset:1024
    buffer_load_dwordx4 v[136:139], v13, s[20:23], s63 offen offset:2048
    buffer_load_dwordx4 v[140:143], v13, s[20:23], s63 offen offset:3072
    s_add_u32 s63, s82, 20480
    buffer_load_dwordx4 v[144:147], v13, s[20:23], s63 offen offset:0
    buffer_load_dwordx4 v[148:151], v13, s[20:23], s63 offen offset:1024
    buffer_load_dwordx4 v[152:155], v13, s[20:23], s63 offen offset:2048
    buffer_load_dwordx4 v[156:159], v13, s[20:23], s63 offen offset:3072
    v_add_f32 v16, 0x3089705f, v28
    v_rcp_f32 v16, v16
    s_nop 0
    v_mul_f32 v16, 0.25, v16
    s_nop 7
    v_pk_mul_f32 v[32:33], v[32:33], v[16:17] op_sel_hi:[1,0]
    v_pk_mul_f32 v[34:35], v[34:35], v[16:17] op_sel_hi:[1,0]
    v_cvt_pk_bf16_f32 v32, v32, v33
    v_cvt_pk_bf16_f32 v33, v34, v35
    v_pk_mul_f32 v[36:37], v[36:37], v[16:17] op_sel_hi:[1,0]
    v_pk_mul_f32 v[38:39], v[38:39], v[16:17] op_sel_hi:[1,0]
    v_cvt_pk_bf16_f32 v36, v36, v37
    v_cvt_pk_bf16_f32 v37, v38, v39
    v_pk_mul_f32 v[40:41], v[40:41], v[16:17] op_sel_hi:[1,0]
    v_pk_mul_f32 v[42:43], v[42:43], v[16:17] op_sel_hi:[1,0]
    v_cvt_pk_bf16_f32 v40, v40, v41
    v_cvt_pk_bf16_f32 v41, v42, v43
    v_pk_mul_f32 v[44:45], v[44:45], v[16:17] op_sel_hi:[1,0]
    v_pk_mul_f32 v[46:47], v[46:47], v[16:17] op_sel_hi:[1,0]
    v_cvt_pk_bf16_f32 v44, v44, v45
    v_cvt_pk_bf16_f32 v45, v46, v47
    v_pk_mul_f32 v[48:49], v[48:49], v[16:17] op_sel_hi:[1,0]
    v_pk_mul_f32 v[50:51], v[50:51], v[16:17] op_sel_hi:[1,0]
    v_cvt_pk_bf16_f32 v48, v48, v49
    v_cvt_pk_bf16_f32 v49, v50, v51
    v_pk_mul_f32 v[52:53], v[52:53], v[16:17] op_sel_hi:[1,0]
    v_pk_mul_f32 v[54:55], v[54:55], v[16:17] op_sel_hi:[1,0]
    v_cvt_pk_bf16_f32 v52, v52, v53
    v_cvt_pk_bf16_f32 v53, v54, v55
    v_pk_mul_f32 v[56:57], v[56:57], v[16:17] op_sel_hi:[1,0]
    v_pk_mul_f32 v[58:59], v[58:59], v[16:17] op_sel_hi:[1,0]
    v_cvt_pk_bf16_f32 v56, v56, v57
    v_cvt_pk_bf16_f32 v57, v58, v59
    v_pk_mul_f32 v[60:61], v[60:61], v[16:17] op_sel_hi:[1,0]
    v_pk_mul_f32 v[62:63], v[62:63], v[16:17] op_sel_hi:[1,0]
    v_cvt_pk_bf16_f32 v60, v60, v61
    v_cvt_pk_bf16_f32 v61, v62, v63
    v_pk_mul_f32 v[64:65], v[64:65], v[16:17] op_sel_hi:[1,0]
    v_pk_mul_f32 v[66:67], v[66:67], v[16:17] op_sel_hi:[1,0]
    v_cvt_pk_bf16_f32 v64, v64, v65
    v_cvt_pk_bf16_f32 v65, v66, v67
    v_pk_mul_f32 v[68:69], v[68:69], v[16:17] op_sel_hi:[1,0]
    v_pk_mul_f32 v[70:71], v[70:71], v[16:17] op_sel_hi:[1,0]
    v_cvt_pk_bf16_f32 v68, v68, v69
    v_cvt_pk_bf16_f32 v69, v70, v71
    v_pk_mul_f32 v[72:73], v[72:73], v[16:17] op_sel_hi:[1,0]
    v_pk_mul_f32 v[74:75], v[74:75], v[16:17] op_sel_hi:[1,0]
    v_cvt_pk_bf16_f32 v72, v72, v73
    v_cvt_pk_bf16_f32 v73, v74, v75
    v_pk_mul_f32 v[76:77], v[76:77], v[16:17] op_sel_hi:[1,0]
    v_pk_mul_f32 v[78:79], v[78:79], v[16:17] op_sel_hi:[1,0]
    v_cvt_pk_bf16_f32 v76, v76, v77
    v_cvt_pk_bf16_f32 v77, v78, v79
    v_pk_mul_f32 v[80:81], v[80:81], v[16:17] op_sel_hi:[1,0]
    v_pk_mul_f32 v[82:83], v[82:83], v[16:17] op_sel_hi:[1,0]
    v_cvt_pk_bf16_f32 v80, v80, v81
    v_cvt_pk_bf16_f32 v81, v82, v83
    v_pk_mul_f32 v[84:85], v[84:85], v[16:17] op_sel_hi:[1,0]
    v_pk_mul_f32 v[86:87], v[86:87], v[16:17] op_sel_hi:[1,0]
    v_cvt_pk_bf16_f32 v84, v84, v85
    v_cvt_pk_bf16_f32 v85, v86, v87
    v_pk_mul_f32 v[88:89], v[88:89], v[16:17] op_sel_hi:[1,0]
    v_pk_mul_f32 v[90:91], v[90:91], v[16:17] op_sel_hi:[1,0]
    v_cvt_pk_bf16_f32 v88, v88, v89
    v_cvt_pk_bf16_f32 v89, v90, v91
    v_pk_mul_f32 v[92:93], v[92:93], v[16:17] op_sel_hi:[1,0]
    v_pk_mul_f32 v[94:95], v[94:95], v[16:17] op_sel_hi:[1,0]
    v_cvt_pk_bf16_f32 v92, v92, v93
    v_cvt_pk_bf16_f32 v93, v94, v95
    v_lshrrev_b32 v16, 2, v1
    v_mul_u32_u24 v17, 2080, v16
    s_mul_i32 s51, s36, 17056
    s_add_u32 s51, s51, 23808
    v_and_b32 v14, 3, v1
    v_lshl_add_u32 v17, v14, 3, v17
    v_lshl_add_u32 v17, v2, 5, v17
    v_add_u32 v17, s51, v17
    s_mov_b64 exec, s[80:81]
    ds_write_b64 v17, v[96:97] offset:0
    ds_write_b64 v17, v[98:99] offset:128
    ds_write_b64 v17, v[100:101] offset:256
    ds_write_b64 v17, v[102:103] offset:384
    ds_write_b64 v17, v[104:105] offset:512
    ds_write_b64 v17, v[106:107] offset:640
    ds_write_b64 v17, v[108:109] offset:768
    ds_write_b64 v17, v[110:111] offset:896
    ds_write_b64 v17, v[112:113] offset:1024
    ds_write_b64 v17, v[114:115] offset:1152
    ds_write_b64 v17, v[116:117] offset:1280
    ds_write_b64 v17, v[118:119] offset:1408
    ds_write_b64 v17, v[120:121] offset:1536
    ds_write_b64 v17, v[122:123] offset:1664
    ds_write_b64 v17, v[124:125] offset:1792
    ds_write_b64 v17, v[126:127] offset:1920
    s_mov_b64 exec, s[14:15]
    ds_write_b64 v17, v[32:33] offset:6240
    ds_write_b64 v17, v[36:37] offset:6368
    ds_write_b64 v17, v[40:41] offset:6496
    ds_write_b64 v17, v[44:45] offset:6624
    ds_write_b64 v17, v[48:49] offset:6752
    ds_write_b64 v17, v[52:53] offset:6880
    ds_write_b64 v17, v[56:57] offset:7008
    ds_write_b64 v17, v[60:61] offset:7136
    ds_write_b64 v17, v[64:65] offset:7264
    ds_write_b64 v17, v[68:69] offset:7392
    ds_write_b64 v17, v[72:73] offset:7520
    ds_write_b64 v17, v[76:77] offset:7648
    ds_write_b64 v17, v[80:81] offset:7776
    ds_write_b64 v17, v[84:85] offset:7904
    ds_write_b64 v17, v[88:89] offset:8032
    ds_write_b64 v17, v[92:93] offset:8160
    s_mov_b64 exec, -1
    v_add_u32 v16, 0, v1
    v_mul_u32_u24 v14, 13, v16
    v_lshrrev_b32 v14, 6, v14
    v_mad_i32_i24 v16, v14, -5, v16
    v_mul_u32_u24 v14, 17056, v14
    v_mul_u32_u24 v16, 2080, v16
    v_add3_u32 v6, v16, v14, v8
    v_add_u32 v6, 23808, v6
    v_add_u32 v16, 16, v1
    v_mul_u32_u24 v14, 13, v16
    v_lshrrev_b32 v14, 6, v14
    v_mad_i32_i24 v16, v14, -5, v16
    v_mul_u32_u24 v14, 17056, v14
    v_mul_u32_u24 v16, 2080, v16
    v_add3_u32 v7, v16, v14, v8
    v_add_u32 v7, 23808, v7
    v_add_u32 v16, 32, v1
    v_min_u32 v16, 39, v16
    v_mul_u32_u24 v14, 13, v16
    v_lshrrev_b32 v14, 6, v14
    v_mad_i32_i24 v16, v14, -5, v16
    v_mul_u32_u24 v14, 17056, v14
    v_mul_u32_u24 v16, 2080, v16
    v_add3_u32 v4, v16, v14, v8
    v_add_u32 v4, 23808, v4
    s_mov_b32 s24, s10
    s_and_b32 s25, s11, 0xffff
    s_mov_b32 s26, 5120000
    s_mov_b32 s27, 0x00020000
    s_waitcnt lgkmcnt(0)
    s_add_u32 s63, s82, 24576
    buffer_load_dwordx4 v[68:71], v13, s[20:23], s63 offen offset:0
    buffer_load_dwordx4 v[72:75], v13, s[20:23], s63 offen offset:1024
    buffer_load_dwordx4 v[76:79], v13, s[20:23], s63 offen offset:2048
    buffer_load_dwordx4 v[80:83], v13, s[20:23], s63 offen offset:3072
    s_add_u32 s63, s82, 28672
    buffer_load_dwordx4 v[84:87], v13, s[20:23], s63 offen offset:0
    buffer_load_dwordx4 v[88:91], v13, s[20:23], s63 offen offset:1024
    s_barrier
    ds_read_b128 v[32:35], v6 offset:0
    ds_read_b128 v[36:39], v7 offset:0
    ds_read_b128 v[40:43], v4 offset:0
    ds_read_b128 v[44:47], v6 offset:64
    ds_read_b128 v[48:51], v7 offset:64
    ds_read_b128 v[52:55], v4 offset:64
    ds_read_b128 v[56:59], v6 offset:128
    ds_read_b128 v[60:63], v7 offset:128
    ds_read_b128 v[64:67], v4 offset:128
    s_waitcnt vmcnt(28) lgkmcnt(6)
    v_mfma_f32_16x16x32_bf16 v[96:99], v[160:163], v[32:35], 0
    v_mfma_f32_16x16x32_bf16 v[104:107], v[160:163], v[36:39], 0
    v_mfma_f32_16x16x32_bf16 v[112:115], v[160:163], v[40:43], 0
    v_mfma_f32_16x16x32_bf16 v[100:103], v[164:167], v[32:35], 0
    v_mfma_f32_16x16x32_bf16 v[108:111], v[164:167], v[36:39], 0
    v_mfma_f32_16x16x32_bf16 v[116:119], v[164:167], v[40:43], 0
    buffer_load_dwordx4 v[160:163], v13, s[20:23], s63 offen offset:2048
    buffer_load_dwordx4 v[164:167], v13, s[20:23], s63 offen offset:3072
    ds_read_b128 v[32:35], v6 offset:192
    ds_read_b128 v[36:39], v7 offset:192
    ds_read_b128 v[40:43], v4 offset:192
    s_waitcnt vmcnt(28) lgkmcnt(6)
    v_mfma_f32_16x16x32_bf16 v[96:99], v[168:171], v[44:47], v[96:99]
    v_mfma_f32_16x16x32_bf16 v[104:107], v[168:171], v[48:51], v[104:107]
    v_mfma_f32_16x16x32_bf16 v[112:115], v[168:171], v[52:55], v[112:115]
    v_mfma_f32_16x16x32_bf16 v[100:103], v[172:175], v[44:47], v[100:103]
    v_mfma_f32_16x16x32_bf16 v[108:111], v[172:175], v[48:51], v[108:111]
    v_mfma_f32_16x16x32_bf16 v[116:119], v[172:175], v[52:55], v[116:119]
    s_add_u32 s63, s82, 32768
    buffer_load_dwordx4 v[168:171], v13, s[20:23], s63 offen offset:0
    buffer_load_dwordx4 v[172:175], v13, s[20:23], s63 offen offset:1024
    ds_read_b128 v[44:47], v6 offset:256
    ds_read_b128 v[48:51], v7 offset:256
    ds_read_b128 v[52:55], v4 offset:256
    s_waitcnt vmcnt(28) lgkmcnt(6)
    v_mfma_f32_16x16x32_bf16 v[96:99], v[176:179], v[56:59], v[96:99]
    v_mfma_f32_16x16x32_bf16 v[104:107], v[176:179], v[60:63], v[104:107]
    v_mfma_f32_16x16x32_bf16 v[112:115], v[176:179], v[64:67], v[112:115]
    v_mfma_f32_16x16x32_bf16 v[100:103], v[180:183], v[56:59], v[100:103]
    v_mfma_f32_16x16x32_bf16 v[108:111], v[180:183], v[60:63], v[108:111]
    v_mfma_f32_16x16x32_bf16 v[116:119], v[180:183], v[64:67], v[116:119]
    buffer_load_dwordx4 v[176:179], v13, s[20:23], s63 offen offset:2048
    buffer_load_dwordx4 v[180:183], v13, s[20:23], s63 offen offset:3072
    ds_read_b128 v[56:59], v6 offset:320
    ds_read_b128 v[60:63], v7 offset:320
    ds_read_b128 v[64:67], v4 offset:320
    s_waitcnt vmcnt(28) lgkmcnt(6)
    v_mfma_f32_16x16x32_bf16 v[96:99], v[184:187], v[32:35], v[96:99]
    v_mfma_f32_16x16x32_bf16 v[104:107], v[184:187], v[36:39], v[104:107]
    v_mfma_f32_16x16x32_bf16 v[112:115], v[184:187], v[40:43], v[112:115]
    v_mfma_f32_16x16x32_bf16 v[100:103], v[188:191], v[32:35], v[100:103]
    v_mfma_f32_16x16x32_bf16 v[108:111], v[188:191], v[36:39], v[108:111]
    v_mfma_f32_16x16x32_bf16 v[116:119], v[188:191], v[40:43], v[116:119]
    s_add_u32 s63, s82, 36864
    buffer_load_dwordx4 v[184:187], v13, s[20:23], s63 offen offset:0
    buffer_load_dwordx4 v[188:191], v13, s[20:23], s63 offen offset:1024
    ds_read_b128 v[32:35], v6 offset:384
    ds_read_b128 v[36:39], v7 offset:384
    ds_read_b128 v[40:43], v4 offset:384
    s_waitcnt vmcnt(28) lgkmcnt(6)
    v_mfma_f32_16x16x32_bf16 v[96:99], v[192:195], v[44:47], v[96:99]
    v_mfma_f32_16x16x32_bf16 v[104:107], v[192:195], v[48:51], v[104:107]
    v_mfma_f32_16x16x32_bf16 v[112:115], v[192:195], v[52:55], v[112:115]
    v_mfma_f32_16x16x32_bf16 v[100:103], v[196:199], v[44:47], v[100:103]
    v_mfma_f32_16x16x32_bf16 v[108:111], v[196:199], v[48:51], v[108:111]
    v_mfma_f32_16x16x32_bf16 v[116:119], v[196:199], v[52:55], v[116:119]
    buffer_load_dwordx4 v[192:195], v13, s[20:23], s63 offen offset:2048
    buffer_load_dwordx4 v[196:199], v13, s[20:23], s63 offen offset:3072
    ds_read_b128 v[44:47], v6 offset:448
    ds_read_b128 v[48:51], v7 offset:448
    ds_read_b128 v[52:55], v4 offset:448
    s_waitcnt vmcnt(28) lgkmcnt(6)
    v_mfma_f32_16x16x32_bf16 v[96:99], v[200:203], v[56:59], v[96:99]
    v_mfma_f32_16x16x32_bf16 v[104:107], v[200:203], v[60:63], v[104:107]
    v_mfma_f32_16x16x32_bf16 v[112:115], v[200:203], v[64:67], v[112:115]
    v_mfma_f32_16x16x32_bf16 v[100:103], v[204:207], v[56:59], v[100:103]
    v_mfma_f32_16x16x32_bf16 v[108:111], v[204:207], v[60:63], v[108:111]
    v_mfma_f32_16x16x32_bf16 v[116:119], v[204:207], v[64:67], v[116:119]
    s_add_u32 s63, s82, 40960
    buffer_load_dwordx4 v[200:203], v13, s[20:23], s63 offen offset:0
    buffer_load_dwordx4 v[204:207], v13, s[20:23], s63 offen offset:1024
    ds_read_b128 v[56:59], v6 offset:512
    ds_read_b128 v[60:63], v7 offset:512
    ds_read_b128 v[64:67], v4 offset:512
    s_waitcnt vmcnt(28) lgkmcnt(6)
    v_mfma_f32_16x16x32_bf16 v[96:99], v[208:211], v[32:35], v[96:99]
    v_mfma_f32_16x16x32_bf16 v[104:107], v[208:211], v[36:39], v[104:107]
    v_mfma_f32_16x16x32_bf16 v[112:115], v[208:211], v[40:43], v[112:115]
    v_mfma_f32_16x16x32_bf16 v[100:103], v[212:215], v[32:35], v[100:103]
    v_mfma_f32_16x16x32_bf16 v[108:111], v[212:215], v[36:39], v[108:111]
    v_mfma_f32_16x16x32_bf16 v[116:119], v[212:215], v[40:43], v[116:119]
    buffer_load_dwordx4 v[208:211], v13, s[20:23], s63 offen offset:2048
    buffer_load_dwordx4 v[212:215], v13, s[20:23], s63 offen offset:3072
    ds_read_b128 v[32:35], v6 offset:576
    ds_read_b128 v[36:39], v7 offset:576
    ds_read_b128 v[40:43], v4 offset:576
    s_waitcnt vmcnt(28) lgkmcnt(6)
    v_mfma_f32_16x16x32_bf16 v[96:99], v[216:219], v[44:47], v[96:99]
    v_mfma_f32_16x16x32_bf16 v[104:107], v[216:219], v[48:51], v[104:107]
    v_mfma_f32_16x16x32_bf16 v[112:115], v[216:219], v[52:55], v[112:115]
    v_mfma_f32_16x16x32_bf16 v[100:103], v[220:223], v[44:47], v[100:103]
    v_mfma_f32_16x16x32_bf16 v[108:111], v[220:223], v[48:51], v[108:111]
    v_mfma_f32_16x16x32_bf16 v[116:119], v[220:223], v[52:55], v[116:119]
    s_add_u32 s63, s82, 45056
    buffer_load_dwordx4 v[216:219], v13, s[20:23], s63 offen offset:0
    buffer_load_dwordx4 v[220:223], v13, s[20:23], s63 offen offset:1024
    ds_read_b128 v[44:47], v6 offset:640
    ds_read_b128 v[48:51], v7 offset:640
    ds_read_b128 v[52:55], v4 offset:640
    s_waitcnt vmcnt(28) lgkmcnt(6)
    v_mfma_f32_16x16x32_bf16 v[96:99], v[128:131], v[56:59], v[96:99]
    v_mfma_f32_16x16x32_bf16 v[104:107], v[128:131], v[60:63], v[104:107]
    v_mfma_f32_16x16x32_bf16 v[112:115], v[128:131], v[64:67], v[112:115]
    v_mfma_f32_16x16x32_bf16 v[100:103], v[132:135], v[56:59], v[100:103]
    v_mfma_f32_16x16x32_bf16 v[108:111], v[132:135], v[60:63], v[108:111]
    v_mfma_f32_16x16x32_bf16 v[116:119], v[132:135], v[64:67], v[116:119]
    buffer_load_dwordx4 v[128:131], v13, s[20:23], s63 offen offset:2048
    buffer_load_dwordx4 v[132:135], v13, s[20:23], s63 offen offset:3072
    ds_read_b128 v[56:59], v6 offset:704
    ds_read_b128 v[60:63], v7 offset:704
    ds_read_b128 v[64:67], v4 offset:704
    s_waitcnt vmcnt(28) lgkmcnt(6)
    v_mfma_f32_16x16x32_bf16 v[96:99], v[136:139], v[32:35], v[96:99]
    v_mfma_f32_16x16x32_bf16 v[104:107], v[136:139], v[36:39], v[104:107]
    v_mfma_f32_16x16x32_bf16 v[112:115], v[136:139], v[40:43], v[112:115]
    v_mfma_f32_16x16x32_bf16 v[100:103], v[140:143], v[32:35], v[100:103]
    v_mfma_f32_16x16x32_bf16 v[108:111], v[140:143], v[36:39], v[108:111]
    v_mfma_f32_16x16x32_bf16 v[116:119], v[140:143], v[40:43], v[116:119]
    s_add_u32 s63, s82, 49152
    buffer_load_dwordx4 v[136:139], v13, s[20:23], s63 offen offset:0
    buffer_load_dwordx4 v[140:143], v13, s[20:23], s63 offen offset:1024
    ds_read_b128 v[32:35], v6 offset:768
    ds_read_b128 v[36:39], v7 offset:768
    ds_read_b128 v[40:43], v4 offset:768
    s_waitcnt vmcnt(28) lgkmcnt(6)
    v_mfma_f32_16x16x32_bf16 v[96:99], v[144:147], v[44:47], v[96:99]
    v_mfma_f32_16x16x32_bf16 v[104:107], v[144:147], v[48:51], v[104:107]
    v_mfma_f32_16x16x32_bf16 v[112:115], v[144:147], v[52:55], v[112:115]
    v_mfma_f32_16x16x32_bf16 v[100:103], v[148:151], v[44:47], v[100:103]
    v_mfma_f32_16x16x32_bf16 v[108:111], v[148:151], v[48:51], v[108:111]
    v_mfma_f32_16x16x32_bf16 v[116:119], v[148:151], v[52:55], v[116:119]
    buffer_load_dwordx4 v[144:147], v13, s[20:23], s63 offen offset:2048
    buffer_load_dwordx4 v[148:151], v13, s[20:23], s63 offen offset:3072
    ds_read_b128 v[44:47], v6 offset:832
    ds_read_b128 v[48:51], v7 offset:832
    ds_read_b128 v[52:55], v4 offset:832
    s_waitcnt vmcnt(28) lgkmcnt(6)
    v_mfma_f32_16x16x32_bf16 v[96:99], v[152:155], v[56:59], v[96:99]
    v_mfma_f32_16x16x32_bf16 v[104:107], v[152:155], v[60:63], v[104:107]
    v_mfma_f32_16x16x32_bf16 v[112:115], v[152:155], v[64:67], v[112:115]
    v_mfma_f32_16x16x32_bf16 v[100:103], v[156:159], v[56:59], v[100:103]
    v_mfma_f32_16x16x32_bf16 v[108:111], v[156:159], v[60:63], v[108:111]
    v_mfma_f32_16x16x32_bf16 v[116:119], v[156:159], v[64:67], v[116:119]
    s_add_u32 s63, s82, 53248
    buffer_load_dwordx4 v[152:155], v13, s[20:23], s63 offen offset:0
    buffer_load_dwordx4 v[156:159], v13, s[20:23], s63 offen offset:1024
    ds_read_b128 v[56:59], v6 offset:896
    ds_read_b128 v[60:63], v7 offset:896
    ds_read_b128 v[64:67], v4 offset:896
    s_waitcnt vmcnt(28) lgkmcnt(6)
    v_mfma_f32_16x16x32_bf16 v[96:99], v[68:71], v[32:35], v[96:99]
    v_mfma_f32_16x16x32_bf16 v[104:107], v[68:71], v[36:39], v[104:107]
    v_mfma_f32_16x16x32_bf16 v[112:115], v[68:71], v[40:43], v[112:115]
    v_mfma_f32_16x16x32_bf16 v[100:103], v[72:75], v[32:35], v[100:103]
    v_mfma_f32_16x16x32_bf16 v[108:111], v[72:75], v[36:39], v[108:111]
    v_mfma_f32_16x16x32_bf16 v[116:119], v[72:75], v[40:43], v[116:119]
    buffer_load_dwordx4 v[68:71], v13, s[20:23], s63 offen offset:2048
    buffer_load_dwordx4 v[72:75], v13, s[20:23], s63 offen offset:3072
    ds_read_b128 v[32:35], v6 offset:960
    ds_read_b128 v[36:39], v7 offset:960
    ds_read_b128 v[40:43], v4 offset:960
    s_waitcnt vmcnt(28) lgkmcnt(6)
    v_mfma_f32_16x16x32_bf16 v[96:99], v[76:79], v[44:47], v[96:99]
    v_mfma_f32_16x16x32_bf16 v[104:107], v[76:79], v[48:51], v[104:107]
    v_mfma_f32_16x16x32_bf16 v[112:115], v[76:79], v[52:55], v[112:115]
    v_mfma_f32_16x16x32_bf16 v[100:103], v[80:83], v[44:47], v[100:103]
    v_mfma_f32_16x16x32_bf16 v[108:111], v[80:83], v[48:51], v[108:111]
    v_mfma_f32_16x16x32_bf16 v[116:119], v[80:83], v[52:55], v[116:119]
    s_add_u32 s63, s82, 57344
    buffer_load_dwordx4 v[76:79], v13, s[20:23], s63 offen offset:0
    buffer_load_dwordx4 v[80:83], v13, s[20:23], s63 offen offset:1024
    ds_read_b128 v[44:47], v6 offset:1024
    ds_read_b128 v[48:51], v7 offset:1024
    ds_read_b128 v[52:55], v4 offset:1024
    s_waitcnt vmcnt(28) lgkmcnt(6)
    v_mfma_f32_16x16x32_bf16 v[96:99], v[84:87], v[56:59], v[96:99]
    v_mfma_f32_16x16x32_bf16 v[104:107], v[84:87], v[60:63], v[104:107]
    v_mfma_f32_16x16x32_bf16 v[112:115], v[84:87], v[64:67], v[112:115]
    v_mfma_f32_16x16x32_bf16 v[100:103], v[88:91], v[56:59], v[100:103]
    v_mfma_f32_16x16x32_bf16 v[108:111], v[88:91], v[60:63], v[108:111]
    v_mfma_f32_16x16x32_bf16 v[116:119], v[88:91], v[64:67], v[116:119]
    buffer_load_dwordx4 v[84:87], v13, s[20:23], s63 offen offset:2048
    buffer_load_dwordx4 v[88:91], v13, s[20:23], s63 offen offset:3072
    ds_read_b128 v[56:59], v6 offset:1088
    ds_read_b128 v[60:63], v7 offset:1088
    ds_read_b128 v[64:67], v4 offset:1088
    s_waitcnt vmcnt(28) lgkmcnt(6)
    v_mfma_f32_16x16x32_bf16 v[96:99], v[160:163], v[32:35], v[96:99]
    v_mfma_f32_16x16x32_bf16 v[104:107], v[160:163], v[36:39], v[104:107]
    v_mfma_f32_16x16x32_bf16 v[112:115], v[160:163], v[40:43], v[112:115]
    v_mfma_f32_16x16x32_bf16 v[100:103], v[164:167], v[32:35], v[100:103]
    v_mfma_f32_16x16x32_bf16 v[108:111], v[164:167], v[36:39], v[108:111]
    v_mfma_f32_16x16x32_bf16 v[116:119], v[164:167], v[40:43], v[116:119]
    s_add_u32 s63, s82, 61440
    buffer_load_dwordx4 v[160:163], v13, s[20:23], s63 offen offset:0
    buffer_load_dwordx4 v[164:167], v13, s[20:23], s63 offen offset:1024
    ds_read_b128 v[32:35], v6 offset:1152
    ds_read_b128 v[36:39], v7 offset:1152
    ds_read_b128 v[40:43], v4 offset:1152
    s_waitcnt vmcnt(28) lgkmcnt(6)
    v_mfma_f32_16x16x32_bf16 v[96:99], v[168:171], v[44:47], v[96:99]
    v_mfma_f32_16x16x32_bf16 v[104:107], v[168:171], v[48:51], v[104:107]
    v_mfma_f32_16x16x32_bf16 v[112:115], v[168:171], v[52:55], v[112:115]
    v_mfma_f32_16x16x32_bf16 v[100:103], v[172:175], v[44:47], v[100:103]
    v_mfma_f32_16x16x32_bf16 v[108:111], v[172:175], v[48:51], v[108:111]
    v_mfma_f32_16x16x32_bf16 v[116:119], v[172:175], v[52:55], v[116:119]
    buffer_load_dwordx4 v[168:171], v13, s[20:23], s63 offen offset:2048
    buffer_load_dwordx4 v[172:175], v13, s[20:23], s63 offen offset:3072
    ds_read_b128 v[44:47], v6 offset:1216
    ds_read_b128 v[48:51], v7 offset:1216
    ds_read_b128 v[52:55], v4 offset:1216
    s_waitcnt vmcnt(28) lgkmcnt(6)
    v_mfma_f32_16x16x32_bf16 v[96:99], v[176:179], v[56:59], v[96:99]
    v_mfma_f32_16x16x32_bf16 v[104:107], v[176:179], v[60:63], v[104:107]
    v_mfma_f32_16x16x32_bf16 v[112:115], v[176:179], v[64:67], v[112:115]
    v_mfma_f32_16x16x32_bf16 v[100:103], v[180:183], v[56:59], v[100:103]
    v_mfma_f32_16x16x32_bf16 v[108:111], v[180:183], v[60:63], v[108:111]
    v_mfma_f32_16x16x32_bf16 v[116:119], v[180:183], v[64:67], v[116:119]
    ds_read_b128 v[56:59], v6 offset:1280
    ds_read_b128 v[60:63], v7 offset:1280
    ds_read_b128 v[64:67], v4 offset:1280
    s_waitcnt vmcnt(26) lgkmcnt(6)
    v_mfma_f32_16x16x32_bf16 v[96:99], v[184:187], v[32:35], v[96:99]
    v_mfma_f32_16x16x32_bf16 v[104:107], v[184:187], v[36:39], v[104:107]
    v_mfma_f32_16x16x32_bf16 v[112:115], v[184:187], v[40:43], v[112:115]
    v_mfma_f32_16x16x32_bf16 v[100:103], v[188:191], v[32:35], v[100:103]
    v_mfma_f32_16x16x32_bf16 v[108:111], v[188:191], v[36:39], v[108:111]
    v_mfma_f32_16x16x32_bf16 v[116:119], v[188:191], v[40:43], v[116:119]
    ds_read_b128 v[32:35], v6 offset:1344
    ds_read_b128 v[36:39], v7 offset:1344
    ds_read_b128 v[40:43], v4 offset:1344
    s_waitcnt vmcnt(24) lgkmcnt(6)
    v_mfma_f32_16x16x32_bf16 v[96:99], v[192:195], v[44:47], v[96:99]
    v_mfma_f32_16x16x32_bf16 v[104:107], v[192:195], v[48:51], v[104:107]
    v_mfma_f32_16x16x32_bf16 v[112:115], v[192:195], v[52:55], v[112:115]
    v_mfma_f32_16x16x32_bf16 v[100:103], v[196:199], v[44:47], v[100:103]
    v_mfma_f32_16x16x32_bf16 v[108:111], v[196:199], v[48:51], v[108:111]
    v_mfma_f32_16x16x32_bf16 v[116:119], v[196:199], v[52:55], v[116:119]
    ds_read_b128 v[44:47], v6 offset:1408
    ds_read_b128 v[48:51], v7 offset:1408
    ds_read_b128 v[52:55], v4 offset:1408
    s_waitcnt vmcnt(22) lgkmcnt(6)
    v_mfma_f32_16x16x32_bf16 v[96:99], v[200:203], v[56:59], v[96:99]
    v_mfma_f32_16x16x32_bf16 v[104:107], v[200:203], v[60:63], v[104:107]
    v_mfma_f32_16x16x32_bf16 v[112:115], v[200:203], v[64:67], v[112:115]
    v_mfma_f32_16x16x32_bf16 v[100:103], v[204:207], v[56:59], v[100:103]
    v_mfma_f32_16x16x32_bf16 v[108:111], v[204:207], v[60:63], v[108:111]
    v_mfma_f32_16x16x32_bf16 v[116:119], v[204:207], v[64:67], v[116:119]
    ds_read_b128 v[56:59], v6 offset:1472
    ds_read_b128 v[60:63], v7 offset:1472
    ds_read_b128 v[64:67], v4 offset:1472
    s_waitcnt vmcnt(20) lgkmcnt(6)
    v_mfma_f32_16x16x32_bf16 v[96:99], v[208:211], v[32:35], v[96:99]
    v_mfma_f32_16x16x32_bf16 v[104:107], v[208:211], v[36:39], v[104:107]
    v_mfma_f32_16x16x32_bf16 v[112:115], v[208:211], v[40:43], v[112:115]
    v_mfma_f32_16x16x32_bf16 v[100:103], v[212:215], v[32:35], v[100:103]
    v_mfma_f32_16x16x32_bf16 v[108:111], v[212:215], v[36:39], v[108:111]
    v_mfma_f32_16x16x32_bf16 v[116:119], v[212:215], v[40:43], v[116:119]
    ds_read_b128 v[32:35], v6 offset:1536
    ds_read_b128 v[36:39], v7 offset:1536
    ds_read_b128 v[40:43], v4 offset:1536
    s_waitcnt vmcnt(18) lgkmcnt(6)
    v_mfma_f32_16x16x32_bf16 v[96:99], v[216:219], v[44:47], v[96:99]
    v_mfma_f32_16x16x32_bf16 v[104:107], v[216:219], v[48:51], v[104:107]
    v_mfma_f32_16x16x32_bf16 v[112:115], v[216:219], v[52:55], v[112:115]
    v_mfma_f32_16x16x32_bf16 v[100:103], v[220:223], v[44:47], v[100:103]
    v_mfma_f32_16x16x32_bf16 v[108:111], v[220:223], v[48:51], v[108:111]
    v_mfma_f32_16x16x32_bf16 v[116:119], v[220:223], v[52:55], v[116:119]
    ds_read_b128 v[44:47], v6 offset:1600
    ds_read_b128 v[48:51], v7 offset:1600
    ds_read_b128 v[52:55], v4 offset:1600
    s_waitcnt vmcnt(16) lgkmcnt(6)
    v_mfma_f32_16x16x32_bf16 v[96:99], v[128:131], v[56:59], v[96:99]
    v_mfma_f32_16x16x32_bf16 v[104:107], v[128:131], v[60:63], v[104:107]
    v_mfma_f32_16x16x32_bf16 v[112:115], v[128:131], v[64:67], v[112:115]
    v_mfma_f32_16x16x32_bf16 v[100:103], v[132:135], v[56:59], v[100:103]
    v_mfma_f32_16x16x32_bf16 v[108:111], v[132:135], v[60:63], v[108:111]
    v_mfma_f32_16x16x32_bf16 v[116:119], v[132:135], v[64:67], v[116:119]
    ds_read_b128 v[56:59], v6 offset:1664
    ds_read_b128 v[60:63], v7 offset:1664
    ds_read_b128 v[64:67], v4 offset:1664
    s_waitcnt vmcnt(14) lgkmcnt(6)
    v_mfma_f32_16x16x32_bf16 v[96:99], v[136:139], v[32:35], v[96:99]
    v_mfma_f32_16x16x32_bf16 v[104:107], v[136:139], v[36:39], v[104:107]
    v_mfma_f32_16x16x32_bf16 v[112:115], v[136:139], v[40:43], v[112:115]
    v_mfma_f32_16x16x32_bf16 v[100:103], v[140:143], v[32:35], v[100:103]
    v_mfma_f32_16x16x32_bf16 v[108:111], v[140:143], v[36:39], v[108:111]
    v_mfma_f32_16x16x32_bf16 v[116:119], v[140:143], v[40:43], v[116:119]
    ds_read_b128 v[32:35], v6 offset:1728
    ds_read_b128 v[36:39], v7 offset:1728
    ds_read_b128 v[40:43], v4 offset:1728
    s_waitcnt vmcnt(12) lgkmcnt(6)
    v_mfma_f32_16x16x32_bf16 v[96:99], v[144:147], v[44:47], v[96:99]
    v_mfma_f32_16x16x32_bf16 v[104:107], v[144:147], v[48:51], v[104:107]
    v_mfma_f32_16x16x32_bf16 v[112:115], v[144:147], v[52:55], v[112:115]
    v_mfma_f32_16x16x32_bf16 v[100:103], v[148:151], v[44:47], v[100:103]
    v_mfma_f32_16x16x32_bf16 v[108:111], v[148:151], v[48:51], v[108:111]
    v_mfma_f32_16x16x32_bf16 v[116:119], v[148:151], v[52:55], v[116:119]
    ds_read_b128 v[44:47], v6 offset:1792
    ds_read_b128 v[48:51], v7 offset:1792
    ds_read_b128 v[52:55], v4 offset:1792
    s_waitcnt vmcnt(10) lgkmcnt(6)
    v_mfma_f32_16x16x32_bf16 v[96:99], v[152:155], v[56:59], v[96:99]
    v_mfma_f32_16x16x32_bf16 v[104:107], v[152:155], v[60:63], v[104:107]
    v_mfma_f32_16x16x32_bf16 v[112:115], v[152:155], v[64:67], v[112:115]
    v_mfma_f32_16x16x32_bf16 v[100:103], v[156:159], v[56:59], v[100:103]
    v_mfma_f32_16x16x32_bf16 v[108:111], v[156:159], v[60:63], v[108:111]
    v_mfma_f32_16x16x32_bf16 v[116:119], v[156:159], v[64:67], v[116:119]
    ds_read_b128 v[56:59], v6 offset:1856
    ds_read_b128 v[60:63], v7 offset:1856
    ds_read_b128 v[64:67], v4 offset:1856
    s_waitcnt vmcnt(8) lgkmcnt(6)
    v_mfma_f32_16x16x32_bf16 v[96:99], v[68:71], v[32:35], v[96:99]
    v_mfma_f32_16x16x32_bf16 v[104:107], v[68:71], v[36:39], v[104:107]
    v_mfma_f32_16x16x32_bf16 v[112:115], v[68:71], v[40:43], v[112:115]
    v_mfma_f32_16x16x32_bf16 v[100:103], v[72:75], v[32:35], v[100:103]
    v_mfma_f32_16x16x32_bf16 v[108:111], v[72:75], v[36:39], v[108:111]
    v_mfma_f32_16x16x32_bf16 v[116:119], v[72:75], v[40:43], v[116:119]
    ds_read_b128 v[32:35], v6 offset:1920
    ds_read_b128 v[36:39], v7 offset:1920
    ds_read_b128 v[40:43], v4 offset:1920
    s_waitcnt vmcnt(6) lgkmcnt(6)
    v_mfma_f32_16x16x32_bf16 v[96:99], v[76:79], v[44:47], v[96:99]
    v_mfma_f32_16x16x32_bf16 v[104:107], v[76:79], v[48:51], v[104:107]
    v_mfma_f32_16x16x32_bf16 v[112:115], v[76:79], v[52:55], v[112:115]
    v_mfma_f32_16x16x32_bf16 v[100:103], v[80:83], v[44:47], v[100:103]
    v_mfma_f32_16x16x32_bf16 v[108:111], v[80:83], v[48:51], v[108:111]
    v_mfma_f32_16x16x32_bf16 v[116:119], v[80:83], v[52:55], v[116:119]
    ds_read_b128 v[44:47], v6 offset:1984
    ds_read_b128 v[48:51], v7 offset:1984
    ds_read_b128 v[52:55], v4 offset:1984
    s_waitcnt vmcnt(4) lgkmcnt(6)
    v_mfma_f32_16x16x32_bf16 v[96:99], v[84:87], v[56:59], v[96:99]
    v_mfma_f32_16x16x32_bf16 v[104:107], v[84:87], v[60:63], v[104:107]
    v_mfma_f32_16x16x32_bf16 v[112:115], v[84:87], v[64:67], v[112:115]
    v_mfma_f32_16x16x32_bf16 v[100:103], v[88:91], v[56:59], v[100:103]
    v_mfma_f32_16x16x32_bf16 v[108:111], v[88:91], v[60:63], v[108:111]
    v_mfma_f32_16x16x32_bf16 v[116:119], v[88:91], v[64:67], v[116:119]
    s_waitcnt vmcnt(2) lgkmcnt(3)
    v_mfma_f32_16x16x32_bf16 v[96:99], v[160:163], v[32:35], v[96:99]
    v_mfma_f32_16x16x32_bf16 v[104:107], v[160:163], v[36:39], v[104:107]
    v_mfma_f32_16x16x32_bf16 v[112:115], v[160:163], v[40:43], v[112:115]
    v_mfma_f32_16x16x32_bf16 v[100:103], v[164:167], v[32:35], v[100:103]
    v_mfma_f32_16x16x32_bf16 v[108:111], v[164:167], v[36:39], v[108:111]
    v_mfma_f32_16x16x32_bf16 v[116:119], v[164:167], v[40:43], v[116:119]
    s_waitcnt vmcnt(0) lgkmcnt(0)
    v_mfma_f32_16x16x32_bf16 v[96:99], v[168:171], v[44:47], v[96:99]
    v_mfma_f32_16x16x32_bf16 v[104:107], v[168:171], v[48:51], v[104:107]
    v_mfma_f32_16x16x32_bf16 v[112:115], v[168:171], v[52:55], v[112:115]
    v_mfma_f32_16x16x32_bf16 v[100:103], v[172:175], v[44:47], v[100:103]
    v_mfma_f32_16x16x32_bf16 v[108:111], v[172:175], v[48:51], v[108:111]
    v_mfma_f32_16x16x32_bf16 v[116:119], v[172:175], v[52:55], v[116:119]
    s_mul_i32 s51, s2, 20480
    s_lshl_b32 s52, s36, 6
    s_add_u32 s51, s51, s52
    v_lshlrev_b32 v16, 9, v1
    v_lshl_add_u32 v16, v2, 4, v16
    v_add_u32 v17, 8192, v16
    v_add_u32 v14, 16384, v16
    s_nop 4
    v_cvt_pk_bf16_f32 v160, v96, v97
    v_cvt_pk_bf16_f32 v161, v98, v99
    v_cvt_pk_bf16_f32 v162, v100, v101
    v_cvt_pk_bf16_f32 v163, v102, v103
    buffer_store_dwordx4 v[160:163], v16, s[24:27], s51 offen
    v_cvt_pk_bf16_f32 v164, v104, v105
    v_cvt_pk_bf16_f32 v165, v106, v107
    v_cvt_pk_bf16_f32 v166, v108, v109
    v_cvt_pk_bf16_f32 v167, v110, v111
    buffer_store_dwordx4 v[164:167], v17, s[24:27], s51 offen
    v_cvt_pk_bf16_f32 v168, v112, v113
    v_cvt_pk_bf16_f32 v169, v114, v115
    v_cvt_pk_bf16_f32 v170, v116, v117
    v_cvt_pk_bf16_f32 v171, v118, v119
    s_mov_b64 exec, s[14:15]
    buffer_store_dwordx4 v[168:171], v14, s[24:27], s51 offen
    s_branch K3_END
K3_SLOW:
    s_mov_b32 s49, 1
    s_mov_b32 s28, s6
    s_and_b32 s29, s7, 0xffff
    s_mov_b32 s30, 640000
    s_mov_b32 s31, 0x00020000
    s_mov_b32 s32, s8
    s_and_b32 s33, s9, 0xffff
    s_mov_b32 s34, 640000
    s_mov_b32 s35, 0x00020000
    s_waitcnt vmcnt(0) lgkmcnt(0)
    v_and_b32 v14, 3, v1
    v_lshlrev_b32 v15, 9, v14
    v_lshl_add_u32 v15, v2, 4, v15
    ds_read_b128 v[192:195], v15 offset:4352
    ds_read_b128 v[196:199], v15 offset:4416
    ds_read_b128 v[200:203], v15 offset:4480
    ds_read_b128 v[204:207], v15 offset:4544
    ds_read_b128 v[208:211], v15 offset:4608
    ds_read_b128 v[212:215], v15 offset:4672
    ds_read_b128 v[216:219], v15 offset:4736
    ds_read_b128 v[220:223], v15 offset:4800
    ds_read_b128 v[128:131], v15 offset:2304
    ds_read_b128 v[132:135], v15 offset:2368
    ds_read_b128 v[136:139], v15 offset:2432
    ds_read_b128 v[140:143], v15 offset:2496
    ds_read_b128 v[144:147], v15 offset:2560
    ds_read_b128 v[148:151], v15 offset:2624
    ds_read_b128 v[152:155], v15 offset:2688
    ds_read_b128 v[156:159], v15 offset:2752
    s_lshl_b32 s51, s36, 8
    v_lshlrev_b32 v14, 6, v14
    v_add_u32 v14, s51, v14
    v_lshl_add_u32 v15, v2, 4, v14
    v_lshrrev_b32 v11, 2, v1
    v_lshl_add_u32 v14, v11, 2, v14
    v_cmp_gt_u32 s[64:65], 4, v1
    s_lshl_b32 s51, s36, 4
    v_add_u32 v11, s51, v11
    s_waitcnt lgkmcnt(8)
    v_mfma_f32_16x16x32_bf16 v[236:239], v[160:163], v[192:195], 0
    v_mfma_f32_16x16x32_bf16 v[236:239], v[164:167], v[196:199], v[236:239]
    v_mfma_f32_16x16x32_bf16 v[236:239], v[168:171], v[200:203], v[236:239]
    v_mfma_f32_16x16x32_bf16 v[236:239], v[172:175], v[204:207], v[236:239]
    v_mfma_f32_16x16x32_bf16 v[236:239], v[176:179], v[208:211], v[236:239]
    v_mfma_f32_16x16x32_bf16 v[236:239], v[180:183], v[212:215], v[236:239]
    v_mfma_f32_16x16x32_bf16 v[236:239], v[184:187], v[216:219], v[236:239]
    v_mfma_f32_16x16x32_bf16 v[236:239], v[188:191], v[220:223], v[236:239]
    s_nop 7
    s_mov_b64 exec, s[64:65]
    ds_write_b128 v15, v[236:239] offset:256
    s_mov_b64 exec, -1
    ds_read_b32 v24, v14 offset:256
    ds_read_b32 v12, v14 offset:268
    s_waitcnt lgkmcnt(0)
    v_mov_b32 v25, v24
    v_mov_b32 v26, v24
    v_mov_b32 v27, v24
K3_SLOW_SUB:
    s_mul_i32 s53, s2, 40
    s_mul_i32 s51, s36, 5
    s_add_u32 s53, s53, s51
    s_mul_i32 s51, s43, 3
    s_add_u32 s53, s53, s51
    s_sub_u32 s54, 3, s43
    s_lshl_b32 s55, s36, 1
    s_add_u32 s55, s55, s43
    s_lshl_b32 s55, s55, 3
    s_mov_b32 s56, 0
    s_mov_b32 s57, 0
    s_mov_b32 s58, 0
    s_mov_b32 s41, s37
    v_lshlrev_b32 v14, 2, v3
K3_SLOW_SCAN:
    buffer_load_dword v232, v14, s[32:35], s57 offen
    buffer_load_dword v233, v14, s[28:31], s57 offen
    s_waitcnt vmcnt(0)
    v_subrev_u32 v232, s53, v232
    v_cmp_gt_u32 vcc, s54, v232
    s_nop 1
    s_cbranch_vccz K3_SLOW_NEXT
    v_mbcnt_lo_u32_b32 v234, vcc_lo, 0
    v_mbcnt_hi_u32_b32 v234, vcc_hi, v234
    v_add_u32 v234, s56, v234
    v_lshlrev_b32 v234, 2, v234
    v_add_u32 v234, s37, v234
    v_or_b32 v232, s55, v232
    v_lshl_or_b32 v232, v233, 9, v232
    s_bcnt1_i32_b64 s51, vcc
    s_mov_b64 exec, vcc
    ds_write_b32 v234, v232
    s_mov_b64 exec, -1
    s_add_u32 s56, s56, s51
K3_SLOW_CHK:
    s_cmp_lt_u32 s56, 16
    s_cbranch_scc1 K3_SLOW_NEXT
K3_SLOW_PROC:
    v_add_u32 v17, s37, v9
    ds_read_b128 v[224:227], v17 offset:0
    ds_read_b128 v[228:231], v17 offset:16
    s_waitcnt lgkmcnt(0)
    s_mov_b32 m0, s47
    v_and_or_b32 v224, v224, s50, v10
    buffer_load_dwordx4 v224, s[16:19], 0 offen lds
    s_add_u32 m0, m0, 1056
    v_and_or_b32 v225, v225, s50, v10
    buffer_load_dwordx4 v225, s[16:19], 0 offen lds
    s_add_u32 m0, m0, 1056
    v_and_or_b32 v226, v226, s50, v10
    buffer_load_dwordx4 v226, s[16:19], 0 offen lds
    s_add_u32 m0, m0, 1056
    v_and_or_b32 v227, v227, s50, v10
    buffer_load_dwordx4 v227, s[16:19], 0 offen lds
    s_add_u32 m0, m0, 1056
    v_and_or_b32 v228, v228, s50, v10
    buffer_load_dwordx4 v228, s[16:19], 0 offen lds
    s_add_u32 m0, m0, 1056
    v_and_or_b32 v229, v229, s50, v10
    buffer_load_dwordx4 v229, s[16:19], 0 offen lds
    s_add_u32 m0, m0, 1056
    v_and_or_b32 v230, v230, s50, v10
    buffer_load_dwordx4 v230, s[16:19], 0 offen lds
    s_add_u32 m0, m0, 1056
    v_and_or_b32 v231, v231, s50, v10
    buffer_load_dwordx4 v231, s[16:19], 0 offen lds
    s_waitcnt vmcnt(0)
    v_add_u32 v6, s47, v4
    v_add_u32 v7, s47, v5
    v_add_u32 v16, s41, v8
    ds_read_b128 v[160:163], v6 offset:0
    ds_read_b128 v[164:167], v6 offset:64
    ds_read_b128 v[168:171], v6 offset:128
    ds_read_b128 v[172:175], v6 offset:192
    ds_read_b128 v[176:179], v6 offset:256
    ds_read_b128 v[180:183], v6 offset:320
    ds_read_b128 v[184:187], v6 offset:384
    ds_read_b128 v[188:191], v6 offset:448
    ds_read_b128 v[232:235], v16
    ds_read_b64_tr_b16 v[192:193], v7 offset:0
    ds_read_b64_tr_b16 v[194:195], v7 offset:32
    ds_read_b64_tr_b16 v[196:197], v7 offset:64
    ds_read_b64_tr_b16 v[198:199], v7 offset:96
    ds_read_b64_tr_b16 v[200:201], v7 offset:128
    ds_read_b64_tr_b16 v[202:203], v7 offset:160
    ds_read_b64_tr_b16 v[204:205], v7 offset:192
    ds_read_b64_tr_b16 v[206:207], v7 offset:224
    ds_read_b64_tr_b16 v[208:209], v7 offset:256
    ds_read_b64_tr_b16 v[210:211], v7 offset:288
    ds_read_b64_tr_b16 v[212:213], v7 offset:320
    ds_read_b64_tr_b16 v[214:215], v7 offset:352
    ds_read_b64_tr_b16 v[216:217], v7 offset:384
    ds_read_b64_tr_b16 v[218:219], v7 offset:416
    ds_read_b64_tr_b16 v[220:221], v7 offset:448
    ds_read_b64_tr_b16 v[222:223], v7 offset:480
    s_waitcnt lgkmcnt(15)
    v_mfma_f32_16x16x32_bf16 v[236:239], v[160:163], v[128:131], v[24:27]
    v_mfma_f32_16x16x32_bf16 v[236:239], v[164:167], v[132:135], v[236:239]
    v_mfma_f32_16x16x32_bf16 v[236:239], v[168:171], v[136:139], v[236:239]
    v_mfma_f32_16x16x32_bf16 v[236:239], v[172:175], v[140:143], v[236:239]
    v_mfma_f32_16x16x32_bf16 v[236:239], v[176:179], v[144:147], v[236:239]
    v_mfma_f32_16x16x32_bf16 v[236:239], v[180:183], v[148:151], v[236:239]
    v_mfma_f32_16x16x32_bf16 v[236:239], v[184:187], v[152:155], v[236:239]
    v_mfma_f32_16x16x32_bf16 v[236:239], v[188:191], v[156:159], v[236:239]
    v_cmp_eq_u32_sdwa s[64:65], v232, v11 src0_sel:BYTE_0 src1_sel:DWORD
    v_cmp_eq_u32_sdwa s[66:67], v233, v11 src0_sel:BYTE_0 src1_sel:DWORD
    v_cmp_eq_u32_sdwa s[68:69], v234, v11 src0_sel:BYTE_0 src1_sel:DWORD
    v_cmp_eq_u32_sdwa s[70:71], v235, v11 src0_sel:BYTE_0 src1_sel:DWORD
    s_waitcnt lgkmcnt(0)
    s_nop 7
    s_cmp_eq_u32 s60, 1
    s_cbranch_scc1 PT_2_NF
    s_nop 3
    v_mul_f32 v240, 0x3e4ccccd, v236
    v_mul_f32 v241, 0x3e4ccccd, v237
    v_mul_f32 v242, 0x3e4ccccd, v238
    v_mul_f32 v243, 0x3e4ccccd, v239
    v_max_f32 v240, v236, v240
    v_max_f32 v241, v237, v241
    v_max_f32 v242, v238, v242
    v_max_f32 v243, v239, v243
    v_exp_f32 v240, v240
    v_exp_f32 v241, v241
    v_exp_f32 v242, v242
    v_exp_f32 v243, v243
    v_cndmask_b32 v240, 0, v240, s[64:65]
    v_cndmask_b32 v241, 0, v241, s[66:67]
    v_cndmask_b32 v242, 0, v242, s[68:69]
    v_cndmask_b32 v243, 0, v243, s[70:71]
    v_cvt_pk_bf16_f32 v18, v240, v241
    v_cvt_pk_bf16_f32 v19, v242, v243
    s_nop 1
    v_mfma_f32_16x16x16_bf16 v[28:31], v[20:21], v[18:19], v[28:31]
    v_mfma_f32_16x16x16_bf16 v[32:35], v[192:193], v[18:19], v[32:35]
    v_mfma_f32_16x16x16_bf16 v[36:39], v[194:195], v[18:19], v[36:39]
    v_mfma_f32_16x16x16_bf16 v[40:43], v[196:197], v[18:19], v[40:43]
    v_mfma_f32_16x16x16_bf16 v[44:47], v[198:199], v[18:19], v[44:47]
    v_mfma_f32_16x16x16_bf16 v[48:51], v[200:201], v[18:19], v[48:51]
    v_mfma_f32_16x16x16_bf16 v[52:55], v[202:203], v[18:19], v[52:55]
    v_mfma_f32_16x16x16_bf16 v[56:59], v[204:205], v[18:19], v[56:59]
    v_mfma_f32_16x16x16_bf16 v[60:63], v[206:207], v[18:19], v[60:63]
    v_mfma_f32_16x16x16_bf16 v[64:67], v[208:209], v[18:19], v[64:67]
    v_mfma_f32_16x16x16_bf16 v[68:71], v[210:211], v[18:19], v[68:71]
    v_mfma_f32_16x16x16_bf16 v[72:75], v[212:213], v[18:19], v[72:75]
    v_mfma_f32_16x16x16_bf16 v[76:79], v[214:215], v[18:19], v[76:79]
    v_mfma_f32_16x16x16_bf16 v[80:83], v[216:217], v[18:19], v[80:83]
    v_mfma_f32_16x16x16_bf16 v[84:87], v[218:219], v[18:19], v[84:87]
    v_mfma_f32_16x16x16_bf16 v[88:91], v[220:221], v[18:19], v[88:91]
    v_mfma_f32_16x16x16_bf16 v[92:95], v[222:223], v[18:19], v[92:95]
    s_branch PT_2_E
PT_2_NF:
    s_nop 3
    v_mul_f32 v240, 0x3e4ccccd, v236
    v_mul_f32 v241, 0x3e4ccccd, v237
    v_mul_f32 v242, 0x3e4ccccd, v238
    v_mul_f32 v243, 0x3e4ccccd, v239
    v_max_f32 v240, v236, v240
    v_max_f32 v241, v237, v241
    v_max_f32 v242, v238, v242
    v_max_f32 v243, v239, v243
    v_exp_f32 v240, v240
    v_exp_f32 v241, v241
    v_exp_f32 v242, v242
    v_exp_f32 v243, v243
    v_cndmask_b32 v240, 0, v240, s[64:65]
    v_cndmask_b32 v241, 0, v241, s[66:67]
    v_cndmask_b32 v242, 0, v242, s[68:69]
    v_cndmask_b32 v243, 0, v243, s[70:71]
    v_cvt_pk_bf16_f32 v18, v240, v241
    v_cvt_pk_bf16_f32 v19, v242, v243
    s_nop 1
    v_mfma_f32_16x16x16_bf16 v[28:31], v[20:21], v[18:19], 0
    v_mfma_f32_16x16x16_bf16 v[32:35], v[192:193], v[18:19], 0
    v_mfma_f32_16x16x16_bf16 v[36:39], v[194:195], v[18:19], 0
    v_mfma_f32_16x16x16_bf16 v[40:43], v[196:197], v[18:19], 0
    v_mfma_f32_16x16x16_bf16 v[44:47], v[198:199], v[18:19], 0
    v_mfma_f32_16x16x16_bf16 v[48:51], v[200:201], v[18:19], 0
    v_mfma_f32_16x16x16_bf16 v[52:55], v[202:203], v[18:19], 0
    v_mfma_f32_16x16x16_bf16 v[56:59], v[204:205], v[18:19], 0
    v_mfma_f32_16x16x16_bf16 v[60:63], v[206:207], v[18:19], 0
    v_mfma_f32_16x16x16_bf16 v[64:67], v[208:209], v[18:19], 0
    v_mfma_f32_16x16x16_bf16 v[68:71], v[210:211], v[18:19], 0
    v_mfma_f32_16x16x16_bf16 v[72:75], v[212:213], v[18:19], 0
    v_mfma_f32_16x16x16_bf16 v[76:79], v[214:215], v[18:19], 0
    v_mfma_f32_16x16x16_bf16 v[80:83], v[216:217], v[18:19], 0
    v_mfma_f32_16x16x16_bf16 v[84:87], v[218:219], v[18:19], 0
    v_mfma_f32_16x16x16_bf16 v[88:91], v[220:221], v[18:19], 0
    v_mfma_f32_16x16x16_bf16 v[92:95], v[222:223], v[18:19], 0
PT_2_E:
    s_mov_b32 s60, 0
    s_cmp_eq_u32 s58, 1
    s_cbranch_scc1 K3_FIN
    v_add_u32 v232, s37, v14
    ds_read_b32 v233, v232 offset:64
    ds_read_b32 v234, v232 offset:320
    s_waitcnt lgkmcnt(0)
    ds_write_b32 v232, v233
    ds_write_b32 v232, v234 offset:256
    s_sub_u32 s56, s56, 16
    s_branch K3_SLOW_CHK
K3_SLOW_NEXT:
    s_add_u32 s57, s57, 256
    s_cmp_lt_u32 s57, 640000
    s_cbranch_scc1 K3_SLOW_SCAN
    v_add_u32 v232, s37, v14
    v_mov_b32 v233, s62
    v_cmp_le_u32 vcc, s56, v3
    s_mov_b64 exec, vcc
    ds_write_b32 v232, v233
    s_mov_b64 exec, -1
    s_mov_b32 s58, 1
    s_branch K3_SLOW_PROC
K3_END:
    s_endpgm
K3_CODE_END:
.section .rodata,"a"
.p2align 6
.amdhsa_kernel gat_prep_kernel
  .amdhsa_next_free_vgpr 48
  .amdhsa_next_free_sgpr 48
  .amdhsa_accum_offset 48
  .amdhsa_group_segment_fixed_size 0
  .amdhsa_kernarg_size 72
  .amdhsa_user_sgpr_count 2
  .amdhsa_user_sgpr_kernarg_segment_ptr 1
  .amdhsa_system_sgpr_workgroup_id_x 1
.end_amdhsa_kernel
.p2align 6
.amdhsa_kernel standalone__graph_attention_gat__graph_kernel
  .amdhsa_next_free_vgpr 256
  .amdhsa_next_free_sgpr 102
  .amdhsa_accum_offset 256
  .amdhsa_group_segment_fixed_size 0
  .amdhsa_kernarg_size 72
  .amdhsa_user_sgpr_count 2
  .amdhsa_user_sgpr_kernarg_segment_ptr 1
  .amdhsa_system_sgpr_workgroup_id_x 1
.end_amdhsa_kernel
```
